```python
import torch

def _softmax(x, axis=-1):
    return torch.softmax(x, dim=axis)
def _gelu(x):
    return torch.nn.functional.gelu(x, approximate="tanh")
def _silu(x):
    return torch.nn.functional.silu(x)
def _sigmoid(x):
    return torch.sigmoid(x)
def _layernorm(x, axis=-1, eps=1e-5):
    m = x.mean(dim=axis, keepdim=True)
    v = x.var(dim=axis, keepdim=True, unbiased=False)
    return (x - m) / torch.sqrt(v + eps)
def _scatter_add(tgt, idx, src, axis=0):
    return tgt.clone().index_add_(axis, idx, src)
def _segment_sum(src, seg, n):
    out = torch.zeros((n,) + src.shape[1:], dtype=src.dtype)
    return out.index_add_(0, seg, src)
def _pad(x, pw):
    flat = tuple(v for pair in reversed(pw) for v in pair)
    return torch.nn.functional.pad(x, flat)

kernel_name = 'standalone__cheap_equivariant_egnn__graph'

def setup_inputs():

    _w = (lambda a: (lambda t: t.to(torch.bfloat16) if t.is_floating_point() else t)(torch.as_tensor(a)))
    N, deg, D, De = 10000, 16, 256, max(0, 1)
    E = N * deg
    return {
        "h": _w((lambda *s: torch.randn(*s, dtype=torch.bfloat16) * 0.2)(N, D)),
        "pos": _w((lambda *s: torch.randn(*s, dtype=torch.bfloat16) * 0.8)(N, 3)),
        "e_attr": _w((lambda *s: torch.randn(*s, dtype=torch.bfloat16) * 0.8)(E, De)),
        "src": _w((lambda lo, hi, *s: torch.randint(lo, hi, s))(0, N, E).to(torch.int64)),
        "dst": _w((lambda lo, hi, *s: torch.randint(lo, hi, s))(0, N, E).to(torch.int64)),
        "w_e": _w(0.1 * (lambda *s: torch.randn(*s, dtype=torch.bfloat16) * 0.8)(2 * D + 1 + De, D)),
        "w_x": _w(0.1 * (lambda *s: torch.randn(*s, dtype=torch.bfloat16) * 0.2)(D, 1)),
        "w_h": _w(0.1 * (lambda *s: torch.randn(*s, dtype=torch.bfloat16) * 0.2)(2 * D, D)),
    }

def reference(h, pos, e_attr, src, dst, w_e, w_x, w_h):
    N, D = h.shape[0], h.shape[1]
    diff = pos[dst] - pos[src]
    dist2 = torch.sum(diff * diff, axis=-1, keepdims=True)
    e_in = torch.concatenate([h[dst], h[src], dist2, e_attr], axis=-1)
    m_ij = _silu(e_in @ w_e)
    coord_scale = m_ij @ w_x
    pos_new = pos + _segment_sum(diff * coord_scale, dst, N)
    m_i = _segment_sum(m_ij, dst, N)
    h_new = h + _silu(torch.concatenate([h, m_i], axis=-1) @ w_h)
    return h_new, pos_new
```

```asm
; @launch kernel=prep_kernel grid=(256,1,1) block=(640,1,1) lds=111616
; @launch kernel=edge_kernel grid=(256,1,1) block=(512,1,1) lds=163328
.amdgcn_target "amdgcn-amd-amdhsa--gfx950"
.text
.globl prep_kernel
.p2align 8
.type prep_kernel,@function
prep_kernel:
    s_cmp_ge_u32 s2, 256
    s_cbranch_scc1 K1_END
    s_load_dwordx16 s[4:19], s[0:1], 0
    s_load_dwordx2 s[20:21], s[0:1], 80
    s_cmp_ge_u32 s2, 8
    s_cbranch_scc1 K1_NOPF
    s_getpc_b64 s[22:23]
    s_and_b32 s22, s22, 0xffffff80
    v_lshlrev_b32 v2, 6, v0
    v_min_u32 v2, CODE_END - prep_kernel - 256, v2
    global_load_dword v123, v2, s[22:23]
K1_NOPF:
    v_lshrrev_b32 v10, 6, v0
    v_and_b32 v1, 63, v0
    v_readfirstlane_b32 s56, v10
    v_mov_b32 v8, 0
    v_mov_b32 v9, 0
    v_lshlrev_b32 v10, 3, v0
    v_add_u32 v10, 106496, v10
    ds_write_b64 v10, v[8:9]
    s_and_b32 s60, s2, 7
    s_lshl_b32 s60, s60, 4
    s_lshr_b32 s61, s2, 4
    s_add_u32 s57, s60, s61
    s_bfe_u32 s58, s2, 0x10003
    s_mul_i32 s60, s2, 640
    v_add_u32 v10, s60, v0
    v_lshlrev_b32 v11, 2, v10
    v_lshlrev_b32 v10, 1, v10
    v_lshrrev_b32 v25, 4, v1
    v_and_b32 v26, 15, v1
    v_xor_b32 v28, v26, v25
    v_lshlrev_b32 v28, 4, v28
    v_lshl_or_b32 v28, v25, 9, v28
    v_lshlrev_b32 v30, 1, v25
    v_xor_b32 v30, v26, v30
    v_lshlrev_b32 v30, 4, v30
    v_lshl_or_b32 v30, v25, 9, v30
    s_lshl_b32 s60, s56, 6
    s_and_b32 s61, s60, 192
    v_xor_b32 v28, s61, v28
    v_xor_b32 v29, 128, v28
    s_and_b32 s61, s60, 128
    v_xor_b32 v30, s61, v30
    v_xor_b32 v31, 128, v30
    s_mul_i32 s64, s57, 40960
    s_lshl_b32 s60, s56, 11
    s_add_u32 s64, s64, s60
    s_lshl_b32 s65, s58, 8
    s_add_u32 s65, s65, 131072
    s_add_u32 s65, s65, s60
    s_waitcnt lgkmcnt(0)
    s_mov_b32 s32, s12
    s_and_b32 s33, s13, 0xffff
    s_mov_b32 s34, 640000
    s_mov_b32 s35, 0x20000
    buffer_load_dword v2, v11, s[32:35], 0 offen nt
    s_mov_b32 s36, s10
    s_and_b32 s37, s11, 0xffff
    s_mov_b32 s38, 640000
    s_mov_b32 s39, 0x20000
    buffer_load_dword v3, v11, s[36:39], 0 offen nt
    s_mov_b32 s40, s8
    s_and_b32 s41, s9, 0xffff
    s_mov_b32 s42, 320000
    s_mov_b32 s43, 0x20000
    buffer_load_ushort v4, v10, s[40:43], 0 offen nt
    s_mov_b32 s24, s4
    s_and_b32 s25, s5, 0xffff
    s_mov_b32 s26, 5120000
    s_mov_b32 s27, 0x20000
    s_mov_b32 s28, s14
    s_and_b32 s29, s15, 0xffff
    s_mov_b32 s30, 263168
    s_mov_b32 s31, 0x20000
    s_barrier
    s_lshl_b32 s68, s56, 10
    s_add_u32 m0, s68, 0
    s_add_u32 s61, s64, 0
    buffer_load_dwordx4 v28, s[24:27], s61 offen nt lds
    s_add_u32 m0, s68, 10240
    s_add_u32 s61, s64, 20480
    buffer_load_dwordx4 v29, s[24:27], s61 offen nt lds
    s_add_u32 m0, s68, 40960
    s_add_u32 s61, s65, 0
    buffer_load_dwordx4 v30, s[28:31], s61 offen  lds
    s_add_u32 m0, s68, 51200
    s_add_u32 s61, s65, 20480
    buffer_load_dwordx4 v31, s[28:31], s61 offen  lds
    s_add_u32 m0, s68, 61440
    s_add_u32 s61, s65, 40960
    buffer_load_dwordx4 v30, s[28:31], s61 offen  lds
    s_cmp_ge_u32 s56, 2
    s_cbranch_scc1 K1_ND0
    s_add_u32 m0, s68, 71680
    s_add_u32 s61, s65, 61440
    buffer_load_dwordx4 v31, s[28:31], s61 offen  lds
K1_ND0:
    s_waitcnt vmcnt(5)
    v_lshrrev_b32 v10, 3, v2
    v_lshlrev_b32 v5, 2, v10
    v_add_u32 v5, 106496, v5
    s_cmp_lt_u32 s2, 250
    s_cselect_b32 s60, 1, 0
    v_mov_b32 v11, s60
    ds_add_rtn_u32 v6, v5, v11
    s_mov_b32 s44, s20
    s_and_b32 s45, s21, 0xffff
    s_mov_b32 s46, 7311360
    s_mov_b32 s47, 0x20000
    s_lshl_b32 s61, s2, 11
    s_add_u32 s61, s61, 6912000
    v_lshl_add_u32 v24, v0, 4, s61
    s_sub_u32 s60, s56, 6
    s_cmp_lt_u32 s60, 2
    s_cselect_b32 s59, 1, 0
    s_cmp_lt_u32 s2, 192
    s_cselect_b32 s59, s59, 0
    s_cmp_eq_u32 s59, 0
    s_cbranch_scc1 K1_NOFRAG
    s_cmp_lt_u32 s2, 64
    s_cselect_b32 s48, s14, s18
    s_cselect_b32 s49, s15, s19
    s_cselect_b32 s62, 1, 0
    s_and_b32 s49, s49, 0xffff
    s_mov_b32 s50, 262144
    s_mov_b32 s51, 0x20000
    s_and_b32 s61, s2, 63
    s_lshl_b32 s61, s61, 1
    s_add_u32 s60, s60, s61
    s_and_b32 s61, s60, 8
    s_lshl_b32 s62, s61, s62
    s_lshr_b32 s61, s60, 4
    s_lshl_b32 s61, s61, 6
    s_add_u32 s61, s61, s62
    s_and_b32 s60, s60, 7
    s_lshl_b32 s60, s60, 14
    s_add_u32 s61, s61, s60
    v_and_b32 v11, 3, v1
    v_bfe_u32 v25, v1, 2, 2
    v_lshl_or_b32 v26, v25, 3, v11
    s_cmp_ge_u32 s2, 64
    s_cbranch_scc1 K1_FCOL
    v_bfe_u32 v25, v1, 2, 1
    v_lshl_or_b32 v11, v25, 4, v11
    v_bfe_u32 v25, v1, 3, 1
    v_lshl_or_b32 v26, v25, 2, v11
K1_FCOL:
    v_lshlrev_b32 v11, 1, v26
    v_lshrrev_b32 v25, 4, v1
    s_cmp_ge_u32 s2, 128
    s_cselect_b32 s62, 11, 12
    s_cselect_b32 s63, 6144, 0
    s_cselect_b32 s60, 131072, 0
    s_add_u32 s61, s61, s60
    v_lshlrev_b32 v25, s62, v25
    v_add3_u32 v11, v11, v25, s61
    buffer_load_ushort v12, v11, s[48:51], 0 offen offset:0
    buffer_load_ushort v13, v11, s[48:51], 0 offen offset:512
    buffer_load_ushort v14, v11, s[48:51], 0 offen offset:1024
    buffer_load_ushort v15, v11, s[48:51], 0 offen offset:1536
    buffer_load_ushort v16, v11, s[48:51], s63 offen offset:2048
    buffer_load_ushort v17, v11, s[48:51], s63 offen offset:2560
    buffer_load_ushort v18, v11, s[48:51], s63 offen offset:3072
    buffer_load_ushort v19, v11, s[48:51], s63 offen offset:3584
K1_NOFRAG:
    v_mul_u32_u24 v11, 52429, v10
    v_lshrrev_b32 v11, 18, v11
    v_mul_u32_u24 v11, 5, v11
    v_sub_u32 v10, v10, v11
    v_and_b32 v11, 7, v2
    v_lshl_or_b32 v11, v10, 3, v11
    v_lshlrev_b32 v8, 9, v3
    v_lshl_or_b32 v4, v11, 16, v4
    s_cmp_ge_u32 s56, 5
    s_cselect_b32 s60, 1, 0
    s_cselect_b32 s61, 5, 0
    s_sub_u32 s61, s56, s61
    v_and_b32 v10, 15, v1
    v_lshrrev_b32 v11, 4, v1
    v_xor_b32 v25, v10, v11
    v_lshlrev_b32 v25, 4, v25
    v_lshl_or_b32 v25, v10, 8, v25
    s_lshl_b32 s62, s61, 12
    v_add_u32 v112, s62, v25
    v_xor_b32 v113, 64, v112
    v_xor_b32 v114, 128, v112
    v_xor_b32 v115, 192, v112
    v_bfe_u32 v10, v1, 2, 2
    v_lshl_or_b32 v25, v11, 3, v10
    v_lshlrev_b32 v25, 8, v25
    v_and_b32 v11, 1, v11
    v_xor_b32 v11, s60, v11
    v_lshl_or_b32 v10, v11, 2, v10
    v_lshl_or_b32 v25, v10, 5, v25
    v_and_b32 v10, 3, v1
    v_lshl_or_b32 v25, v10, 3, v25
    v_add_u32 v116, 40960, v25
    v_xor_b32 v117, 32, v116
    v_xor_b32 v118, 64, v116
    v_xor_b32 v119, 96, v116
    s_mul_i32 s63, s57, 80
    s_lshl_b32 s61, s61, 4
    s_add_u32 s63, s63, s61
    s_lshl_b32 s63, s63, 9
    s_lshl_b32 s61, s58, 1
    s_add_u32 s60, s60, s61
    s_lshl_b32 s60, s60, 7
    s_add_u32 s63, s63, s60
    v_and_b32 v10, 15, v1
    v_lshrrev_b32 v11, 4, v1
    v_and_b32 v25, 7, v1
    v_xor_b32 v11, v11, v25
    v_lshlrev_b32 v11, 4, v11
    v_lshl_or_b32 v11, v10, 7, v11
    s_lshl_b32 s60, s56, 11
    v_add_u32 v121, s60, v11
    v_lshrrev_b32 v10, 3, v1
    v_xor_b32 v11, v10, v25
    v_lshlrev_b32 v11, 4, v11
    v_lshl_or_b32 v11, v10, 7, v11
    v_add_u32 v122, s60, v11
    v_lshlrev_b32 v25, 4, v25
    v_lshl_or_b32 v120, v10, 9, v25
    s_and_b32 s60, s2, 7
    s_lshl_b32 s60, s60, 8
    s_and_b32 s61, s2, 0xf8
    s_add_u32 s60, s60, s61
    v_lshl_add_u32 v82, v1, 13, s60
    s_cmp_eq_u32 s59, 0
    s_cbranch_scc1 K1_W0
    s_waitcnt vmcnt(8) lgkmcnt(0)
    s_branch K1_W1
K1_W0:
    s_waitcnt vmcnt(0) lgkmcnt(0)
K1_W1:
    v_lshl_or_b32 v9, v6, 22, v4
    s_barrier
    s_add_u32 m0, s68, 20480
    s_add_u32 s61, s64, 256
    buffer_load_dwordx4 v28, s[24:27], s61 offen nt lds
    s_add_u32 m0, s68, 30720
    s_add_u32 s61, s64, 20736
    buffer_load_dwordx4 v29, s[24:27], s61 offen nt lds
    s_add_u32 m0, s68, 73728
    s_add_u32 s61, s65, 65536
    buffer_load_dwordx4 v30, s[28:31], s61 offen  lds
    s_add_u32 m0, s68, 83968
    s_add_u32 s61, s65, 86016
    buffer_load_dwordx4 v31, s[28:31], s61 offen  lds
    s_add_u32 m0, s68, 94208
    s_add_u32 s61, s65, 106496
    buffer_load_dwordx4 v30, s[28:31], s61 offen  lds
    s_cmp_ge_u32 s56, 2
    s_cbranch_scc1 K1_ND1
    s_add_u32 m0, s68, 104448
    s_add_u32 s61, s65, 126976
    buffer_load_dwordx4 v31, s[28:31], s61 offen  lds
K1_ND1:
    s_cmp_lg_u32 s56, 2
    s_cbranch_scc1 K1_NOSCAN
    v_mul_u32_u24 v10, 80, v1
    v_add_u32 v10, 106496, v10
    ds_read_b128 v[32:35], v10 offset:0
    ds_read_b128 v[36:39], v10 offset:16
    ds_read_b128 v[40:43], v10 offset:32
    ds_read_b128 v[44:47], v10 offset:48
    ds_read_b128 v[48:51], v10 offset:64
    s_waitcnt lgkmcnt(0)
    v_add_u32 v33, v32, v33
    v_add_u32 v34, v33, v34
    v_add_u32 v35, v34, v35
    v_add_u32 v36, v35, v36
    v_add_u32 v37, v36, v37
    v_add_u32 v38, v37, v38
    v_add_u32 v39, v38, v39
    v_add_u32 v40, v39, v40
    v_add_u32 v41, v40, v41
    v_add_u32 v42, v41, v42
    v_add_u32 v43, v42, v43
    v_add_u32 v44, v43, v44
    v_add_u32 v45, v44, v45
    v_add_u32 v46, v45, v46
    v_add_u32 v47, v46, v47
    v_add_u32 v48, v47, v48
    v_add_u32 v49, v48, v49
    v_add_u32 v50, v49, v50
    v_add_u32 v51, v50, v51
    v_mov_b32 v11, v51
    s_nop 1
    v_add_u32_dpp v11, v11, v11 row_shr:1 row_mask:0xf bank_mask:0xf bound_ctrl:0
    s_nop 1
    v_add_u32_dpp v11, v11, v11 row_shr:2 row_mask:0xf bank_mask:0xf bound_ctrl:0
    s_nop 1
    v_add_u32_dpp v11, v11, v11 row_shr:4 row_mask:0xf bank_mask:0xf bound_ctrl:0
    s_nop 1
    v_add_u32_dpp v11, v11, v11 row_shr:8 row_mask:0xf bank_mask:0xf bound_ctrl:0
    s_nop 1
    v_add_u32_dpp v11, v11, v11 row_bcast:15 row_mask:0xa bank_mask:0xf
    s_nop 1
    v_add_u32_dpp v11, v11, v11 row_bcast:31 row_mask:0xc bank_mask:0xf
    v_sub_u32 v52, v11, v51
    v_add_u32 v53, v52, v32
    v_add_u32 v54, v52, v33
    v_add_u32 v55, v52, v34
    v_add_u32 v56, v52, v35
    v_add_u32 v57, v52, v36
    v_add_u32 v58, v52, v37
    v_add_u32 v59, v52, v38
    v_add_u32 v60, v52, v39
    v_add_u32 v61, v52, v40
    v_add_u32 v62, v52, v41
    v_add_u32 v63, v52, v42
    v_add_u32 v64, v52, v43
    v_add_u32 v65, v52, v44
    v_add_u32 v66, v52, v45
    v_add_u32 v67, v52, v46
    v_add_u32 v68, v52, v47
    v_add_u32 v69, v52, v48
    v_add_u32 v70, v52, v49
    v_add_u32 v71, v52, v50
    v_add_u32 v72, v52, v51
    ds_write_b128 v10, v[52:55] offset:0
    ds_write_b128 v10, v[56:59] offset:16
    ds_write_b128 v10, v[60:63] offset:32
    ds_write_b128 v10, v[64:67] offset:48
    ds_write_b128 v10, v[68:71] offset:64
    v_lshl_or_b32 v74, v53, 10, v52
    v_lshl_or_b32 v74, v54, 20, v74
    v_lshl_or_b32 v75, v56, 10, v55
    v_lshl_or_b32 v75, v57, 20, v75
    v_lshl_or_b32 v76, v58, 10, v57
    v_lshl_or_b32 v76, v59, 20, v76
    v_lshl_or_b32 v77, v61, 10, v60
    v_lshl_or_b32 v77, v62, 20, v77
    v_lshl_or_b32 v78, v63, 10, v62
    v_lshl_or_b32 v78, v64, 20, v78
    v_lshl_or_b32 v79, v66, 10, v65
    v_lshl_or_b32 v79, v67, 20, v79
    v_lshl_or_b32 v80, v68, 10, v67
    v_lshl_or_b32 v80, v69, 20, v80
    v_lshl_or_b32 v81, v71, 10, v70
    v_lshl_or_b32 v81, v72, 20, v81
    s_waitcnt lgkmcnt(0)
K1_NOSCAN:
    ds_read_b128 v[104:107], v112 offset:0
    ds_read_b64_tr_b16 v[32:33], v116 offset:0
    ds_read_b64_tr_b16 v[34:35], v116 offset:1024
    ds_read_b64_tr_b16 v[36:37], v117 offset:0
    ds_read_b64_tr_b16 v[38:39], v117 offset:1024
    ds_read_b64_tr_b16 v[40:41], v118 offset:0
    ds_read_b64_tr_b16 v[42:43], v118 offset:1024
    ds_read_b64_tr_b16 v[44:45], v119 offset:0
    ds_read_b64_tr_b16 v[46:47], v119 offset:1024
    s_waitcnt lgkmcnt(0)
    ds_read_b128 v[108:111], v113 offset:0
    ds_read_b64_tr_b16 v[48:49], v116 offset:8192
    ds_read_b64_tr_b16 v[50:51], v116 offset:9216
    v_mfma_f32_16x16x32_bf16 v[88:91], v[32:35], v[104:107], 0
    ds_read_b64_tr_b16 v[52:53], v117 offset:8192
    ds_read_b64_tr_b16 v[54:55], v117 offset:9216
    ds_read_b64_tr_b16 v[56:57], v118 offset:8192
    v_mfma_f32_16x16x32_bf16 v[92:95], v[36:39], v[104:107], 0
    ds_read_b64_tr_b16 v[58:59], v118 offset:9216
    ds_read_b64_tr_b16 v[60:61], v119 offset:8192
    ds_read_b64_tr_b16 v[62:63], v119 offset:9216
    v_mfma_f32_16x16x32_bf16 v[96:99], v[40:43], v[104:107], 0
    v_mfma_f32_16x16x32_bf16 v[100:103], v[44:47], v[104:107], 0
    s_waitcnt lgkmcnt(0)
    ds_read_b128 v[104:107], v114 offset:0
    ds_read_b64_tr_b16 v[32:33], v116 offset:16384
    ds_read_b64_tr_b16 v[34:35], v116 offset:17408
    v_mfma_f32_16x16x32_bf16 v[88:91], v[48:51], v[108:111], v[88:91]
    ds_read_b64_tr_b16 v[36:37], v117 offset:16384
    ds_read_b64_tr_b16 v[38:39], v117 offset:17408
    ds_read_b64_tr_b16 v[40:41], v118 offset:16384
    v_mfma_f32_16x16x32_bf16 v[92:95], v[52:55], v[108:111], v[92:95]
    ds_read_b64_tr_b16 v[42:43], v118 offset:17408
    ds_read_b64_tr_b16 v[44:45], v119 offset:16384
    ds_read_b64_tr_b16 v[46:47], v119 offset:17408
    v_mfma_f32_16x16x32_bf16 v[96:99], v[56:59], v[108:111], v[96:99]
    v_mfma_f32_16x16x32_bf16 v[100:103], v[60:63], v[108:111], v[100:103]
    s_waitcnt lgkmcnt(0)
    ds_read_b128 v[108:111], v115 offset:0
    ds_read_b64_tr_b16 v[48:49], v116 offset:24576
    ds_read_b64_tr_b16 v[50:51], v116 offset:25600
    v_mfma_f32_16x16x32_bf16 v[88:91], v[32:35], v[104:107], v[88:91]
    ds_read_b64_tr_b16 v[52:53], v117 offset:24576
    ds_read_b64_tr_b16 v[54:55], v117 offset:25600
    ds_read_b64_tr_b16 v[56:57], v118 offset:24576
    v_mfma_f32_16x16x32_bf16 v[92:95], v[36:39], v[104:107], v[92:95]
    ds_read_b64_tr_b16 v[58:59], v118 offset:25600
    ds_read_b64_tr_b16 v[60:61], v119 offset:24576
    ds_read_b64_tr_b16 v[62:63], v119 offset:25600
    v_mfma_f32_16x16x32_bf16 v[96:99], v[40:43], v[104:107], v[96:99]
    v_mfma_f32_16x16x32_bf16 v[100:103], v[44:47], v[104:107], v[100:103]
    s_waitcnt lgkmcnt(0)
    v_mfma_f32_16x16x32_bf16 v[88:91], v[48:51], v[108:111], v[88:91]
    v_mfma_f32_16x16x32_bf16 v[92:95], v[52:55], v[108:111], v[92:95]
    v_mfma_f32_16x16x32_bf16 v[96:99], v[56:59], v[108:111], v[96:99]
    v_mfma_f32_16x16x32_bf16 v[100:103], v[60:63], v[108:111], v[100:103]
    s_waitcnt vmcnt(0)
    s_barrier
    ds_read_b32 v10, v5
    s_add_u32 s36, s20, 5124096
    s_addc_u32 s37, s21, 0
    s_and_b32 s37, s37, 0xffff
    s_mov_b32 s38, 1280000
    s_mov_b32 s39, 0x20000
    s_mul_i32 s60, s2, 5120
    s_waitcnt lgkmcnt(0)
    v_add_lshl_u32 v10, v10, v6, 3
    buffer_store_dwordx2 v[8:9], v10, s[36:39], s60 offen
    s_cmp_lg_u32 s56, 2
    s_cbranch_scc1 K1_NOREC
    s_add_u32 s52, s20, 6404096
    s_addc_u32 s53, s21, 0
    s_and_b32 s53, s53, 0xffff
    s_mov_b32 s54, 512000
    s_mov_b32 s55, 0x20000
    s_mov_b32 s60, 0
    buffer_store_dwordx2 v[74:75], v82, s[52:55], s60 offen
    s_mov_b32 s60, 2048
    buffer_store_dwordx2 v[76:77], v82, s[52:55], s60 offen
    s_mov_b32 s60, 4096
    buffer_store_dwordx2 v[78:79], v82, s[52:55], s60 offen
    s_mov_b32 s60, 6144
    buffer_store_dwordx2 v[80:81], v82, s[52:55], s60 offen
K1_NOREC:
    s_mov_b32 s40, s6
    s_and_b32 s41, s7, 0xffff
    s_mov_b32 s42, 60000
    s_mov_b32 s43, 0x20000
    s_lshr_b32 s60, s2, 3
    s_lshl_b32 s60, s60, 11
    v_lshlrev_b32 v11, 2, v0
    buffer_load_dword v25, v11, s[40:43], s60 offen
    ds_read_b128 v[104:107], v112 offset:20480
    ds_read_b64_tr_b16 v[32:33], v116 offset:32768
    ds_read_b64_tr_b16 v[34:35], v116 offset:33792
    ds_read_b64_tr_b16 v[36:37], v117 offset:32768
    ds_read_b64_tr_b16 v[38:39], v117 offset:33792
    ds_read_b64_tr_b16 v[40:41], v118 offset:32768
    ds_read_b64_tr_b16 v[42:43], v118 offset:33792
    ds_read_b64_tr_b16 v[44:45], v119 offset:32768
    ds_read_b64_tr_b16 v[46:47], v119 offset:33792
    s_waitcnt lgkmcnt(0)
    ds_read_b128 v[108:111], v113 offset:20480
    ds_read_b64_tr_b16 v[48:49], v116 offset:40960
    ds_read_b64_tr_b16 v[50:51], v116 offset:41984
    v_mfma_f32_16x16x32_bf16 v[88:91], v[32:35], v[104:107], v[88:91]
    ds_read_b64_tr_b16 v[52:53], v117 offset:40960
    ds_read_b64_tr_b16 v[54:55], v117 offset:41984
    ds_read_b64_tr_b16 v[56:57], v118 offset:40960
    v_mfma_f32_16x16x32_bf16 v[92:95], v[36:39], v[104:107], v[92:95]
    ds_read_b64_tr_b16 v[58:59], v118 offset:41984
    ds_read_b64_tr_b16 v[60:61], v119 offset:40960
    ds_read_b64_tr_b16 v[62:63], v119 offset:41984
    v_mfma_f32_16x16x32_bf16 v[96:99], v[40:43], v[104:107], v[96:99]
    v_mfma_f32_16x16x32_bf16 v[100:103], v[44:47], v[104:107], v[100:103]
    s_waitcnt lgkmcnt(0)
    ds_read_b128 v[104:107], v114 offset:20480
    ds_read_b64_tr_b16 v[32:33], v116 offset:49152
    ds_read_b64_tr_b16 v[34:35], v116 offset:50176
    v_mfma_f32_16x16x32_bf16 v[88:91], v[48:51], v[108:111], v[88:91]
    ds_read_b64_tr_b16 v[36:37], v117 offset:49152
    ds_read_b64_tr_b16 v[38:39], v117 offset:50176
    ds_read_b64_tr_b16 v[40:41], v118 offset:49152
    v_mfma_f32_16x16x32_bf16 v[92:95], v[52:55], v[108:111], v[92:95]
    ds_read_b64_tr_b16 v[42:43], v118 offset:50176
    ds_read_b64_tr_b16 v[44:45], v119 offset:49152
    ds_read_b64_tr_b16 v[46:47], v119 offset:50176
    v_mfma_f32_16x16x32_bf16 v[96:99], v[56:59], v[108:111], v[96:99]
    v_mfma_f32_16x16x32_bf16 v[100:103], v[60:63], v[108:111], v[100:103]
    s_waitcnt lgkmcnt(0)
    ds_read_b128 v[108:111], v115 offset:20480
    ds_read_b64_tr_b16 v[48:49], v116 offset:57344
    ds_read_b64_tr_b16 v[50:51], v116 offset:58368
    v_mfma_f32_16x16x32_bf16 v[88:91], v[32:35], v[104:107], v[88:91]
    ds_read_b64_tr_b16 v[52:53], v117 offset:57344
    ds_read_b64_tr_b16 v[54:55], v117 offset:58368
    ds_read_b64_tr_b16 v[56:57], v118 offset:57344
    v_mfma_f32_16x16x32_bf16 v[92:95], v[36:39], v[104:107], v[92:95]
    ds_read_b64_tr_b16 v[58:59], v118 offset:58368
    ds_read_b64_tr_b16 v[60:61], v119 offset:57344
    ds_read_b64_tr_b16 v[62:63], v119 offset:58368
    v_mfma_f32_16x16x32_bf16 v[96:99], v[40:43], v[104:107], v[96:99]
    v_mfma_f32_16x16x32_bf16 v[100:103], v[44:47], v[104:107], v[100:103]
    s_waitcnt lgkmcnt(0)
    v_mfma_f32_16x16x32_bf16 v[88:91], v[48:51], v[108:111], v[88:91]
    v_mfma_f32_16x16x32_bf16 v[92:95], v[52:55], v[108:111], v[92:95]
    v_mfma_f32_16x16x32_bf16 v[96:99], v[56:59], v[108:111], v[96:99]
    v_mfma_f32_16x16x32_bf16 v[100:103], v[60:63], v[108:111], v[100:103]
    s_add_u32 s32, s20, 4096
    s_addc_u32 s33, s21, 0
    s_and_b32 s33, s33, 0xffff
    s_mov_b32 s34, 5120000
    s_mov_b32 s35, 0x20000
    s_nop 0
    s_mov_b32 s66, 1069066811
    s_mov_b32 s67, 1069066811
    v_pk_mul_f32 v[88:89], v[88:89], s[66:67]
    v_pk_mul_f32 v[90:91], v[90:91], s[66:67]
    v_pk_mul_f32 v[92:93], v[92:93], s[66:67]
    v_pk_mul_f32 v[94:95], v[94:95], s[66:67]
    v_pk_mul_f32 v[96:97], v[96:97], s[66:67]
    v_pk_mul_f32 v[98:99], v[98:99], s[66:67]
    v_pk_mul_f32 v[100:101], v[100:101], s[66:67]
    v_pk_mul_f32 v[102:103], v[102:103], s[66:67]
    v_cvt_pk_bf16_f32 v32, v88, v89
    v_cvt_pk_bf16_f32 v33, v90, v91
    v_cvt_pk_bf16_f32 v34, v92, v93
    v_cvt_pk_bf16_f32 v35, v94, v95
    v_cvt_pk_bf16_f32 v36, v96, v97
    v_cvt_pk_bf16_f32 v37, v98, v99
    v_cvt_pk_bf16_f32 v38, v100, v101
    v_cvt_pk_bf16_f32 v39, v102, v103
    v_xor_b32 v10, 64, v121
    ds_write_b128 v121, v[32:35]
    ds_write_b128 v10, v[36:39]
    ds_read_b128 v[40:43], v122
    ds_read_b128 v[44:47], v122 offset:1024
    s_add_u32 s60, s63, 4096
    s_waitcnt lgkmcnt(1)
    buffer_store_dwordx4 v[40:43], v120, s[32:35], s63 offen sc0 sc1
    s_waitcnt lgkmcnt(0)
    buffer_store_dwordx4 v[44:47], v120, s[32:35], s60 offen sc0 sc1
    s_cmp_eq_u32 s59, 0
    s_cbranch_scc1 K1_NOFST
    v_lshl_or_b32 v20, v13, 16, v12
    v_lshl_or_b32 v21, v15, 16, v14
    v_lshl_or_b32 v22, v17, 16, v16
    v_lshl_or_b32 v23, v19, 16, v18
    buffer_store_dwordx4 v[20:23], v24, s[44:47], 0 offen sc0 sc1
K1_NOFST:
K1_END:
    s_endpgm
.globl edge_kernel
.p2align 8
.type edge_kernel,@function
edge_kernel:
    s_cmp_ge_u32 s2, 256
    s_cbranch_scc1 K2_END
    s_and_b32 s3, s2, 7
    s_lshl_b32 s3, s3, 5
    s_lshr_b32 s2, s2, 3
    s_add_u32 s2, s2, s3
    s_cmp_ge_u32 s2, 250
    s_cbranch_scc1 K2_END
    s_load_dwordx2 s[22:23], s[0:1], 80
    s_load_dwordx16 s[4:19], s[0:1], 0
    s_load_dwordx2 s[20:21], s[0:1], 64
    v_lshrrev_b32 v216, 6, v0
    v_and_b32 v184, 63, v0
    v_readfirstlane_b32 s60, v216
    v_mov_b32 v185, v0
    s_mul_i32 s87, s2, 2048
    s_add_u32 s87, s87, 6404096
    s_mov_b32 s34, 2048
    s_mov_b32 s35, 0x20000
    v_lshrrev_b32 v216, 1, v184
    s_lshl_b32 s80, s60, 8
    v_lshl_add_u32 v218, v216, 3, s80
    v_lshl_add_u32 v197, v216, 3, s60
    v_lshrrev_b32 v219, 5, v184
    v_and_b32 v216, 31, v184
    v_xor_b32 v217, v216, v219
    s_lshl_b32 s82, s60, 1
    v_xor_b32 v217, s82, v217
    v_lshlrev_b32 v217, 4, v217
    v_lshl_or_b32 v217, v219, 9, v217
    v_mul_u32_u24 v197, 640, v197
    v_and_b32 v196, 1, v184
    v_lshlrev_b32 v196, 1, v196
    v_lshlrev_b32 v201, 4, v184
    v_add_u32 v245, 4096, v201
    v_add_u32 v246, 8192, v201
    v_add_u32 v247, 12288, v201
    s_and_b32 s61, s60, 3
    s_lshr_b32 s62, s60, 2
    s_lshl_b32 s99, s60, 14
    s_mov_b32 s63, 1
    s_mov_b32 s64, 0
    s_lshl_b32 s79, s60, 12
    s_add_u32 s79, s79, 130560
    v_mov_b32 v252, v217
    v_mov_b32 v253, v218
    v_mov_b32 v168, 0
    v_mov_b32 v169, 0
    v_mov_b32 v170, 0
    v_mov_b32 v171, 0
    v_lshlrev_b32 v220, 4, v185
    v_add_u32 v221, 65536, v220
    v_cmp_gt_u32 vcc, 480, v185
    v_mov_b32 v248, 1073741824
    v_mov_b32 v249, 1073741824
    v_mov_b32 v250, 1073741824
    v_mov_b32 v251, 1073741824
    s_mov_b64 exec, vcc
    v_cmp_gt_u32 vcc, 224, v185
    ds_write_b128 v221, v[168:171]
    s_mov_b64 exec, vcc
    ds_write_b128 v221, v[168:171] offset:14592
    ds_write_b128 v221, v[248:251] offset:7680
    s_mov_b64 exec, -1
    v_mov_b32 v254, v220
    s_mov_b32 s90, 0xff
    s_mov_b32 s91, 0xff
    s_mov_b32 s100, 2048
    s_mov_b32 s101, 128
    v_and_b32 v216, 15, v184
    v_bfe_u32 v217, v184, 4, 1
    v_lshrrev_b32 v218, 5, v184
    v_lshl_or_b32 v219, v217, 2, v218
    v_bfe_u32 v220, v184, 1, 2
    v_xor_b32 v219, v219, v220
    v_lshlrev_b32 v219, 4, v219
    v_lshl_or_b32 v219, v216, 7, v219
    v_add_u32 v177, s79, v219
    v_xor_b32 v179, 32, v177
    v_cmp_eq_u32 vcc, v217, v218
    v_mov_b32 v219, 768
    v_and_b32 v220, 7, v184
    v_cndmask_b32 v176, 0, v219, vcc
    s_lshl_b32 s80, s61, 7
    v_mul_u32_u24 v219, 528, v220
    v_lshl_add_u32 v219, v218, 3, v219
    s_add_u32 s81, s80, 84608
    v_add_u32 v180, s81, v219
    v_mov_b32 v190, 0
    v_lshlrev_b32 v191, 4, v184
    s_add_u32 s81, s80, 83712
    v_lshl_add_u32 v181, v218, 4, s81
    v_cmp_gt_u32 vcc, 32, v184
    v_mov_b32 v217, 0x3f80
    v_mov_b32 v165, 0
    v_cndmask_b32 v164, 0, v217, vcc
    v_and_b32 v216, 1, v184
    v_lshlrev_b32 v216, 4, v216
    v_lshlrev_b32 v216, v216, v217
    v_bfe_u32 v217, v184, 1, 4
    v_lshlrev_b32 v218, 2, v218
    v_sub_u32 v217, v217, v218
    v_cmp_eq_u32 vcc, 0, v217
    v_cmp_eq_u32 s[82:83], 8, v217
    s_nop 0
    v_cndmask_b32 v156, 0, v216, vcc
    v_cndmask_b32 v160, 0, v216, s[82:83]
    v_cmp_eq_u32 vcc, 1, v217
    v_cmp_eq_u32 s[82:83], 9, v217
    s_nop 0
    v_cndmask_b32 v157, 0, v216, vcc
    v_cndmask_b32 v161, 0, v216, s[82:83]
    v_cmp_eq_u32 vcc, 2, v217
    v_cmp_eq_u32 s[82:83], 10, v217
    s_nop 0
    v_cndmask_b32 v158, 0, v216, vcc
    v_cndmask_b32 v162, 0, v216, s[82:83]
    v_cmp_eq_u32 vcc, 3, v217
    v_cmp_eq_u32 s[82:83], 11, v217
    s_nop 0
    v_cndmask_b32 v159, 0, v216, vcc
    v_cndmask_b32 v163, 0, v216, s[82:83]
    v_lshrrev_b32 v216, 3, v185
    v_lshlrev_b32 v240, 9, v216
    v_and_b32 v217, 1, v185
    v_lshl_or_b32 v240, v217, 3, v240
    v_and_b32 v218, 6, v185
    v_or_b32 v240, v240, v218
    v_lshrrev_b32 v216, 4, v185
    v_mul_u32_u24 v216, 384, v216
    v_bfe_u32 v219, v185, 1, 3
    v_lshl_or_b32 v219, v217, 3, v219
    v_add_u32 v216, 53248, v216
    v_lshl_add_u32 v241, v219, 4, v216
    v_lshl_add_u32 v242, v219, 3, v216
    s_waitcnt lgkmcnt(0)
    s_add_u32 s32, s22, s87
    s_addc_u32 s33, s23, 0
    s_and_b32 s33, s33, 0xffff
    buffer_load_dwordx2 v[192:193], v253, s[32:35], 0 offen
    s_mov_b32 s40, s4
    s_and_b32 s41, s5, 0xffff
    s_mov_b32 s42, 5120000
    s_mov_b32 s43, 0x20000
    s_mul_i32 s80, s2, 20480
    s_lshl_b32 s81, s60, 10
    s_add_u32 s80, s80, s81
    s_add_u32 m0, s81, 110080
    s_nop 0
    buffer_load_dwordx4 v252, s[40:43], s80 offen lds
    s_add_u32 s80, s80, 8192
    s_add_u32 m0, s81, 118272
    s_nop 0
    buffer_load_dwordx4 v252, s[40:43], s80 offen lds
    s_add_u32 s80, s80, 8192
    s_cmp_ge_u32 s60, 4
    s_cbranch_scc1 K2_NOH
    s_add_u32 m0, s81, 126464
    s_nop 0
    buffer_load_dwordx4 v252, s[40:43], s80 offen lds
    s_add_u32 s80, s80, 8192
K2_NOH:
    s_add_u32 s36, s22, 6918144
    s_addc_u32 s37, s23, 0
    s_and_b32 s37, s37, 0xffff
    s_mov_b32 s38, 393216
    s_mov_b32 s39, 0x20000
    v_and_b32 v216, 0x23, v184
    v_bfe_u32 v217, v184, 2, 1
    v_lshl_or_b32 v216, v217, 4, v216
    v_bfe_u32 v217, v184, 3, 2
    ds_write_b128 v254, v[168:171] offset:0
    v_lshl_or_b32 v216, v217, 2, v216
    s_mov_b32 s52, s14
    buffer_load_dwordx4 v[0:3], v201, s[36:39], s99 offen offset:0
    s_and_b32 s53, s15, 0xffff
    s_mov_b32 s54, 263168
    s_mov_b32 s55, 0x20000
    s_lshl_b32 s80, s61, 7
    s_add_u32 s80, s80, 262144
    v_lshlrev_b32 v216, 1, v216
    ds_write_b128 v254, v[168:171] offset:8192
    buffer_load_ushort v212, v216, s[52:55], s80 offen
    buffer_load_ushort v213, v216, s[52:55], s80 offen offset:512
    v_and_b32 v216, 0xe7, v185
    v_bfe_u32 v217, v185, 3, 1
    v_lshl_or_b32 v216, v217, 4, v216
    v_bfe_u32 v217, v185, 4, 1
    buffer_load_dwordx4 v[4:7], v246, s[36:39], s99 offen offset:0
    v_lshl_or_b32 v216, v217, 3, v216
    v_lshlrev_b32 v216, 1, v216
    s_mov_b32 s52, s16
    ds_write_b128 v254, v[168:171] offset:16384
    s_and_b32 s53, s17, 0xffff
    s_mov_b32 s54, 512
    s_mov_b32 s55, 0x20000
    buffer_load_ushort v214, v216, s[52:55], 0 offen
    s_mov_b32 s44, s6
    s_and_b32 s45, s7, 0xffff
    s_mov_b32 s46, 60000
    s_mov_b32 s47, 0x20000
    s_mul_i32 s80, s2, 240
    buffer_load_dwordx4 v[8:11], v201, s[36:39], s99 offen offset:1024
    ds_write_b128 v254, v[168:171] offset:24576
    v_lshlrev_b32 v216, 2, v184
    buffer_load_dword v215, v216, s[44:47], s80 offen
    s_add_u32 s28, s22, 5124096
    s_addc_u32 s29, s23, 0
    s_and_b32 s29, s29, 0xffff
    s_mov_b32 s30, 1280000
    s_mov_b32 s31, 0x20000
    s_add_u32 s24, s22, 1024
    s_addc_u32 s25, s23, 0
    s_and_b32 s25, s25, 0xffff
    ds_write_b128 v254, v[168:171] offset:32768
    s_mov_b32 s26, 5123072
    s_mov_b32 s27, 0x20000
    buffer_load_dwordx4 v[12:15], v246, s[36:39], s99 offen offset:1024
    s_mov_b32 s48, s20
    s_and_b32 s49, s21, 0xffff
    s_mov_b32 s50, 5180000
    s_mov_b32 s51, 0x20000
    s_mul_i32 s80, s2, 43008
    s_add_u32 s80, s80, 16777216
    ds_write_b128 v254, v[168:171] offset:40960
    s_add_u32 s52, s22, s80
    s_addc_u32 s53, s23, 0
    s_and_b32 s53, s53, 0xffff
    s_mov_b32 s54, 43008
    s_mov_b32 s55, 0x20000
    s_mov_b32 s56, 3072
    buffer_load_dwordx4 v[16:19], v201, s[36:39], s99 offen offset:2048
    s_mov_b32 s57, 2048
    s_mov_b32 s58, 1024
    s_lshl_b32 s20, s61, 7
    ds_write_b128 v254, v[168:171] offset:49152
    s_add_u32 s20, s20, 80640
    v_bfe_u32 v219, v184, 4, 2
    v_and_b32 v218, 7, v184
    v_xor_b32 v219, v219, v218
    s_lshl_b32 s80, s61, 7
    v_lshl_add_u32 v178, v219, 4, s80
    v_and_b32 v216, 15, v184
    v_lshrrev_b32 v217, 4, v184
    v_xor_b32 v217, v217, v216
    buffer_load_dwordx4 v[20:23], v246, s[36:39], s99 offen offset:2048
    ds_write_b128 v254, v[168:171] offset:57344
    v_lshlrev_b32 v217, 4, v217
    v_lshl_or_b32 v217, v216, 9, v217
    v_add_u32 v186, 110080, v217
    v_xor_b32 v187, 64, v186
    v_xor_b32 v188, 128, v186
    v_xor_b32 v189, 192, v186
    s_waitcnt vmcnt(12)
K2_BATCH:
    v_and_b32 v195, 1023, v192
    v_lshrrev_b32 v200, 20, v193
    v_sub_u32 v200, v200, v195
    v_add3_u32 v195, v197, v195, v196
    v_sub_u32 v194, v200, v196
    v_lshlrev_b32 v195, 3, v195
    v_cmp_lt_i32 vcc, 0, v194
    v_cmp_lt_i32 s[82:83], 4, v194
    v_mov_b32 v218, 1073741824
    v_cndmask_b32 v217, v218, v195, vcc
    v_cndmask_b32 v218, v218, v195, s[82:83]
    buffer_load_dwordx4 v[204:207], v217, s[28:31], 0 offen
    buffer_load_dwordx4 v[208:211], v218, s[28:31], 0 offen offset:32
    v_lshrrev_b32 v216, 10, v192
    v_lshl_or_b32 v216, v193, 20, v216
    v_and_b32 v216, 0x3fffffff, v216
    v_sub_u32 v216, v216, v192
    v_lshrrev_b32 v217, 10, v193
    v_and_b32 v218, 0xfffff, v193
    buffer_load_dwordx4 v[24:27], v201, s[36:39], s99 offen offset:3072
    v_mov_b32 v198, v216
    v_sub_u32 v217, v217, v218
    v_mov_b32 v199, v217
    v_add_u32_dpp v200, v200, v200 row_shr:2 row_mask:0xf bank_mask:0xf bound_ctrl:0
    v_add_u32_dpp v198, v198, v198 row_shr:2 row_mask:0xf bank_mask:0xf bound_ctrl:0
    v_add_u32_dpp v199, v199, v199 row_shr:2 row_mask:0xf bank_mask:0xf bound_ctrl:0
    v_add_u32_dpp v200, v200, v200 row_shr:4 row_mask:0xf bank_mask:0xf bound_ctrl:0
    v_add_u32_dpp v198, v198, v198 row_shr:4 row_mask:0xf bank_mask:0xf bound_ctrl:0
    v_add_u32_dpp v199, v199, v199 row_shr:4 row_mask:0xf bank_mask:0xf bound_ctrl:0
    v_add_u32_dpp v200, v200, v200 row_shr:8 row_mask:0xf bank_mask:0xf bound_ctrl:0
    v_add_u32_dpp v198, v198, v198 row_shr:8 row_mask:0xf bank_mask:0xf bound_ctrl:0
    v_add_u32_dpp v199, v199, v199 row_shr:8 row_mask:0xf bank_mask:0xf bound_ctrl:0
    v_add_u32_dpp v200, v200, v200 row_bcast:15 row_mask:0xa bank_mask:0xf
    buffer_load_dwordx4 v[28:31], v246, s[36:39], s99 offen offset:3072
    v_add_u32_dpp v198, v198, v198 row_bcast:15 row_mask:0xa bank_mask:0xf
    v_add_u32_dpp v199, v199, v199 row_bcast:15 row_mask:0xa bank_mask:0xf
    v_add_u32_dpp v200, v200, v200 row_bcast:31 row_mask:0xc bank_mask:0xf
    v_add_u32_dpp v198, v198, v198 row_bcast:31 row_mask:0xc bank_mask:0xf
    v_add_u32_dpp v199, v199, v199 row_bcast:31 row_mask:0xc bank_mask:0xf
    s_lshl_b32 s80, s60, 2
    s_add_u32 s80, s80, 84224
    v_mov_b32 v219, s80
    s_mov_b32 exec_lo, 0
    s_mov_b32 exec_hi, 0x80000000
    ds_write_b32 v219, v198 offset:0
    ds_write_b32 v219, v199 offset:32
    ds_write_b32 v219, v200 offset:64
    s_mov_b64 exec, -1
    v_sub_u32 v198, v198, v216
    v_sub_u32 v199, v199, v217
    v_and_b32 v219, 7, v184
    v_lshlrev_b32 v219, 2, v219
    v_add_u32 v219, 84224, v219
    s_waitcnt lgkmcnt(0)
    s_barrier
    ds_read_b32 v216, v219 offset:0
    ds_read_b32 v217, v219 offset:32
    ds_read_b32 v218, v219 offset:64
    buffer_load_dwordx4 v[32:35], v245, s[36:39], s99 offen offset:0
    buffer_load_dwordx4 v[36:39], v247, s[36:39], s99 offen offset:0
    s_mov_b32 s67, 0
    s_waitcnt lgkmcnt(0)
    v_mov_b32 v219, v216
    v_mov_b32 v220, v217
    v_mov_b32 v221, v218
    v_add_u32_dpp v216, v216, v216 row_shr:1 row_mask:0xf bank_mask:0xf bound_ctrl:0
    v_add_u32_dpp v217, v217, v217 row_shr:1 row_mask:0xf bank_mask:0xf bound_ctrl:0
    v_add_u32_dpp v218, v218, v218 row_shr:1 row_mask:0xf bank_mask:0xf bound_ctrl:0
    v_add_u32_dpp v216, v216, v216 row_shr:2 row_mask:0xf bank_mask:0xf bound_ctrl:0
    v_add_u32_dpp v217, v217, v217 row_shr:2 row_mask:0xf bank_mask:0xf bound_ctrl:0
    v_add_u32_dpp v218, v218, v218 row_shr:2 row_mask:0xf bank_mask:0xf bound_ctrl:0
    v_add_u32_dpp v216, v216, v216 row_shr:4 row_mask:0xf bank_mask:0xf bound_ctrl:0
    v_add_u32_dpp v217, v217, v217 row_shr:4 row_mask:0xf bank_mask:0xf bound_ctrl:0
    v_add_u32_dpp v218, v218, v218 row_shr:4 row_mask:0xf bank_mask:0xf bound_ctrl:0
    v_sub_u32 v219, v216, v219
    v_sub_u32 v220, v217, v220
    v_sub_u32 v221, v218, v221
    v_readlane_b32 s80, v216, 7
    v_readlane_b32 s81, v217, 7
    v_readlane_b32 s88, v218, 7
    v_readlane_b32 s82, v219, s60
    v_readlane_b32 s83, v220, s60
    v_readlane_b32 s87, v221, s60
    s_add_u32 s80, s80, 15744015
    s_add_u32 s81, s81, 15375
    s_bfe_u32 s89, s80, 0x60004
    s_add_u32 s68, s67, s89
    s_bfe_u32 s89, s80, 0x6000e
    s_add_u32 s69, s68, s89
    s_bfe_u32 s89, s80, 0x60018
    s_add_u32 s70, s69, s89
    s_bfe_u32 s89, s81, 0x60004
    s_add_u32 s71, s70, s89
    s_bfe_u32 s89, s81, 0x6000e
    s_add_u32 s72, s71, s89
    s_cmp_gt_u32 s88, 832
    s_cselect_b32 s80, 255, s72
    s_cmp_gt_u32 s80, 52
    s_cbranch_scc1 K2_OVER
K2_FITS:
    s_lshl_b32 s80, s68, 14
    s_lshl_b32 s81, s69, 24
    s_add_u32 s82, s82, s80
    s_add_u32 s82, s82, s81
    s_lshl_b32 s80, s70, 4
    s_lshl_b32 s81, s71, 14
    s_add_u32 s83, s83, s80
    s_add_u32 s83, s83, s81
    v_add_u32 v198, s82, v198
    v_add_u32 v199, s83, v199
    v_lshl_or_b32 v202, v199, 30, v198
    v_lshrrev_b32 v203, 2, v199
    s_add_u32 s80, s72, 1
    s_lshr_b32 s80, s80, 1
    s_mul_i32 s89, s80, 42
    s_add_u32 s89, s89, 32
    s_lshr_b32 s89, s89, 6
    s_cmp_lg_u32 s64, 0
    s_cselect_b32 s89, s80, s89
    s_cmp_eq_u32 s62, 0
    s_cselect_b32 s76, 0, s89
    s_cselect_b32 s77, s89, s80
    s_lshl_b32 s80, s76, 7
    s_add_u32 s80, s80, 73216
    v_lshrrev_b32 v216, 3, v184
    v_lshl_add_u32 v173, v216, 3, s80
    v_lshlrev_b32 v243, 2, v185
    v_add_u32 v243, 73216, v243
    s_mov_b32 m0, s79
    s_waitcnt vmcnt(4)
    v_bfe_u32 v216, v205, 19, 3
    v_cmp_lt_i32 vcc, 0, v194
    v_mul_u32_u24 v216, 10, v216
    v_lshrrev_b32 v217, 22, v205
    v_lshrrev_b64 v[218:219], v216, v[202:203]
    v_and_b32 v218, 1023, v218
    v_add_lshl_u32 v218, v218, v217, 2
    v_add_u32 v218, 73216, v218
    s_mov_b64 exec, vcc
    ds_write_b32 v218, v204
    ds_write_b32 v218, v205 offset:3584
    s_mov_b64 exec, -1
    buffer_load_dwordx4 v[40:43], v245, s[36:39], s99 offen offset:1024
    v_bfe_u32 v216, v207, 19, 3
    v_cmp_lt_i32 vcc, 1, v194
    v_mul_u32_u24 v216, 10, v216
    v_lshrrev_b32 v217, 22, v207
    v_lshrrev_b64 v[218:219], v216, v[202:203]
    v_and_b32 v218, 1023, v218
    v_add_lshl_u32 v218, v218, v217, 2
    v_add_u32 v218, 73216, v218
    s_mov_b64 exec, vcc
    ds_write_b32 v218, v206
    ds_write_b32 v218, v207 offset:3584
    s_mov_b64 exec, -1
    buffer_load_dwordx4 v[44:47], v247, s[36:39], s99 offen offset:1024
    buffer_load_dwordx4 v[48:51], v245, s[36:39], s99 offen offset:2048
    v_bfe_u32 v216, v209, 19, 3
    v_cmp_lt_i32 vcc, 4, v194
    v_mul_u32_u24 v216, 10, v216
    v_lshrrev_b32 v217, 22, v209
    v_lshrrev_b64 v[218:219], v216, v[202:203]
    v_and_b32 v218, 1023, v218
    v_add_lshl_u32 v218, v218, v217, 2
    v_add_u32 v218, 73216, v218
    s_mov_b64 exec, vcc
    ds_write_b32 v218, v208
    ds_write_b32 v218, v209 offset:3584
    s_mov_b64 exec, -1
    buffer_load_dwordx4 v[52:55], v247, s[36:39], s99 offen offset:2048
    v_bfe_u32 v216, v211, 19, 3
    v_cmp_lt_i32 vcc, 5, v194
    v_mul_u32_u24 v216, 10, v216
    v_lshrrev_b32 v217, 22, v211
    v_lshrrev_b64 v[218:219], v216, v[202:203]
    v_and_b32 v218, 1023, v218
    v_add_lshl_u32 v218, v218, v217, 2
    v_add_u32 v218, 73216, v218
    s_mov_b64 exec, vcc
    ds_write_b32 v218, v210
    ds_write_b32 v218, v211 offset:3584
    s_mov_b64 exec, -1
    buffer_load_dwordx4 v[56:59], v245, s[36:39], s99 offen offset:3072
    buffer_load_dwordx4 v[60:63], v247, s[36:39], s99 offen offset:3072
    v_cmp_lt_i32 vcc, 8, v194
    s_cmp_eq_u32 s63, 0
    s_cbranch_scc1 K2_NOTAB
    v_and_b32 v216, 255, v185
    v_lshlrev_b32 v216, 1, v216
    v_add_u32 v216, 83712, v216
    ds_write_b16 v216, v214
    v_lshlrev_b32 v216, 2, v184
    v_add_u32 v216, 84352, v216
    ds_write_b32 v216, v215
K2_NOTAB:
    s_cbranch_vccnz K2_MORE
K2_NOMORE:
    s_waitcnt lgkmcnt(0)
    s_barrier
    ds_read2st64_b32 v[228:229], v243 offset1:8
    ds_read2_b64 v[124:127], v173 offset0:0 offset1:8
    v_add_u32 v243, 3584, v243
    ds_read2st64_b32 v[230:231], v243 offset1:8
    v_cmp_gt_u32 vcc, 320, v185
    v_mov_b32 v216, 1073741824
    s_waitcnt lgkmcnt(2)
    v_cndmask_b32 v229, v216, v229, vcc
    v_lshrrev_b32 v232, 9, v228
    v_mul_u32_u24 v232, 6, v232
    v_and_b32 v232, -4, v232
    v_lshrrev_b32 v234, 9, v229
    v_mul_u32_u24 v234, 6, v234
    v_and_b32 v234, -4, v234
    s_mov_b32 s80, 84352
    s_waitcnt lgkmcnt(0)
    v_pk_add_f32 v[124:125], v[124:125], v[178:179] op_sel_hi:[1,0]
    v_pk_add_f32 v[126:127], v[126:127], v[178:179] op_sel_hi:[1,0]
    buffer_load_dwordx4 v124, s[24:27], s56 offen offset:0  lds
    buffer_load_dwordx4 v125, s[24:27], s57 offen offset:1024  lds
    v_bfe_u32 v217, v230, 16, 6
    v_mad_u32_u24 v217, v217, 6, s80
    ds_read_u16_d16_hi v222, v217 offset:0
    ds_read_u16_d16_hi v223, v217 offset:2
    ds_read_u16_d16_hi v224, v217 offset:4
    v_bfe_u32 v217, v231, 16, 6
    v_mad_u32_u24 v217, v217, 6, s80
    ds_read_u16_d16_hi v225, v217 offset:0
    ds_read_u16_d16_hi v226, v217 offset:2
    ds_read_u16_d16_hi v227, v217 offset:4
    s_cmp_eq_u32 s63, 0
    s_cbranch_scc1 K2_NOA
    ds_read_b128 v[88:91], v186 offset:0
    ds_read_b128 v[92:95], v186 offset:8192
    ds_read_b128 v[96:99], v186 offset:16384
    s_waitcnt vmcnt(2) lgkmcnt(0)
    ds_read_b128 v[100:103], v187 offset:0
    ds_read_b128 v[104:107], v187 offset:8192
    ds_read_b128 v[108:111], v187 offset:16384
    v_mfma_f32_16x16x32_bf16 v[64:67], v[88:91], v[0:3], 0
    s_mov_b32 s84, 1069066811
    s_mov_b32 s85, 1069066811
    v_mfma_f32_16x16x32_bf16 v[68:71], v[88:91], v[4:7], 0
    v_lshlrev_b32 v216, 16, v212
    v_mul_f32 v216, s84, v216
    v_cvt_pk_bf16_f32 v217, v216, v216
    v_mfma_f32_16x16x32_bf16 v[72:75], v[92:95], v[0:3], 0
    v_lshlrev_b32 v217, 16, v217
    v_sub_f32 v217, v216, v217
    v_mfma_f32_16x16x32_bf16 v[76:79], v[92:95], v[4:7], 0
    v_cvt_pk_bf16_f32 v152, v216, v217
    v_lshlrev_b32 v216, 16, v213
    v_mul_f32 v216, s84, v216
    v_mfma_f32_16x16x32_bf16 v[80:83], v[96:99], v[0:3], 0
    v_cvt_pk_bf16_f32 v217, v216, v216
    v_lshlrev_b32 v217, 16, v217
    v_mfma_f32_16x16x32_bf16 v[84:87], v[96:99], v[4:7], 0
    v_sub_f32 v217, v216, v217
    v_cvt_pk_bf16_f32 v153, v216, v217
    s_mov_b32 s78, -1
    buffer_load_dwordx2 v[232:233], v232, s[44:47], 0 offen
    buffer_load_dwordx2 v[234:235], v234, s[44:47], 0 offen
    s_waitcnt lgkmcnt(0)
    ds_read_b128 v[88:91], v188 offset:0
    ds_read_b128 v[92:95], v188 offset:8192
    ds_read_b128 v[96:99], v188 offset:16384
    v_mfma_f32_16x16x32_bf16 v[64:67], v[100:103], v[8:11], v[64:67]
    s_mov_b32 s59, 0
    s_add_u32 s86, s99, 262144
    v_mfma_f32_16x16x32_bf16 v[68:71], v[100:103], v[12:15], v[68:71]
    s_mov_b64 s[74:75], 0
    s_bitset1_b64 s[74:75], s68
    s_bitset1_b64 s[74:75], s69
    v_mfma_f32_16x16x32_bf16 v[72:75], v[104:107], v[8:11], v[72:75]
    s_bitset1_b64 s[74:75], s70
    s_bitset1_b64 s[74:75], s71
    v_mfma_f32_16x16x32_bf16 v[76:79], v[104:107], v[12:15], v[76:79]
    s_lshl_b32 s87, s76, 1
    s_lshr_b64 s[74:75], s[74:75], s87
    s_or_b32 s74, s74, 1
    v_mfma_f32_16x16x32_bf16 v[80:83], v[108:111], v[8:11], v[80:83]
    s_lshl_b64 s[74:75], s[74:75], 1
    s_mov_b32 s73, 0
    v_mfma_f32_16x16x32_bf16 v[84:87], v[108:111], v[12:15], v[84:87]
    s_lshl_b32 s80, s73, 8
    s_or_b32 s80, s80, 16
    s_cmp_gt_u32 s71, s87
    buffer_load_dwordx4 v126, s[24:27], s58 offen offset:2048  lds
    buffer_load_dwordx4 v127, s[24:27], 0 offen offset:3072  lds
    s_waitcnt lgkmcnt(0)
    ds_read_b128 v[100:103], v189 offset:0
    ds_read_b128 v[104:107], v189 offset:8192
    ds_read_b128 v[108:111], v189 offset:16384
    v_mfma_f32_16x16x32_bf16 v[64:67], v[88:91], v[16:19], v[64:67]
    s_cselect_b32 s73, s80, s73
    s_lshl_b32 s80, s73, 8
    v_mfma_f32_16x16x32_bf16 v[68:71], v[88:91], v[20:23], v[68:71]
    s_or_b32 s80, s80, 12
    s_cmp_lg_u32 s70, s71
    s_cselect_b32 s80, s80, s73
    v_mfma_f32_16x16x32_bf16 v[72:75], v[92:95], v[16:19], v[72:75]
    s_cmp_gt_u32 s70, s87
    s_cselect_b32 s73, s80, s73
    v_mfma_f32_16x16x32_bf16 v[76:79], v[92:95], v[20:23], v[76:79]
    s_lshl_b32 s80, s73, 8
    s_or_b32 s80, s80, 8
    s_cmp_lg_u32 s69, s70
    v_mfma_f32_16x16x32_bf16 v[80:83], v[96:99], v[16:19], v[80:83]
    s_cselect_b32 s80, s80, s73
    s_cmp_gt_u32 s69, s87
    v_mfma_f32_16x16x32_bf16 v[84:87], v[96:99], v[20:23], v[84:87]
    s_cselect_b32 s73, s80, s73
    s_lshl_b32 s80, s73, 8
    s_or_b32 s80, s80, 4
    s_waitcnt lgkmcnt(0)
    ds_read_b128 v[88:91], v186 offset:256
    ds_read_b128 v[92:95], v186 offset:8448
    ds_read_b128 v[96:99], v186 offset:16640
    v_mfma_f32_16x16x32_bf16 v[64:67], v[100:103], v[24:27], v[64:67]
    s_cmp_lg_u32 s68, s69
    s_cselect_b32 s80, s80, s73
    v_mfma_f32_16x16x32_bf16 v[68:71], v[100:103], v[28:31], v[68:71]
    s_cmp_gt_u32 s68, s87
    s_cselect_b32 s73, s80, s73
    s_mov_b32 s3, s73
    v_mfma_f32_16x16x32_bf16 v[72:75], v[104:107], v[24:27], v[72:75]
    s_mov_b32 s22, 0
    s_cmp_ge_u32 s87, s68
    v_mfma_f32_16x16x32_bf16 v[76:79], v[104:107], v[28:31], v[76:79]
    s_addc_u32 s22, s22, 0
    s_cmp_ge_u32 s87, s69
    s_addc_u32 s22, s22, 0
    v_mfma_f32_16x16x32_bf16 v[80:83], v[108:111], v[24:27], v[80:83]
    s_cmp_ge_u32 s87, s70
    s_addc_u32 s22, s22, 0
    v_mfma_f32_16x16x32_bf16 v[84:87], v[108:111], v[28:31], v[84:87]
    s_cmp_ge_u32 s87, s71
    s_addc_u32 s22, s22, 0
    s_lshl_b32 s22, s22, 2
    s_waitcnt lgkmcnt(0)
    ds_read_b128 v[100:103], v187 offset:256
    ds_read_b128 v[104:107], v187 offset:8448
    ds_read_b128 v[108:111], v187 offset:16640
    v_mfma_f32_16x16x32_bf16 v[64:67], v[88:91], v[32:35], v[64:67]
    s_lshl_b32 s80, s76, 11
    v_add_u32 v172, s80, v201
    v_mfma_f32_16x16x32_bf16 v[68:71], v[88:91], v[36:39], v[68:71]
    s_mul_i32 s80, s76, 768
    s_add_u32 s80, s80, 53248
    v_mfma_f32_16x16x32_bf16 v[72:75], v[92:95], v[32:35], v[72:75]
    s_add_u32 s81, s80, 256
    v_and_b32 v216, 15, v184
    v_cmp_eq_u32 vcc, 0, v176
    v_mfma_f32_16x16x32_bf16 v[76:79], v[92:95], v[36:39], v[76:79]
    v_lshl_add_u32 v220, v216, 4, s80
    v_lshl_add_u32 v221, v216, 3, s81
    v_mfma_f32_16x16x32_bf16 v[80:83], v[96:99], v[32:35], v[80:83]
    v_mov_b32 v217, 80128
    v_cndmask_b32 v174, v220, v217, vcc
    v_mfma_f32_16x16x32_bf16 v[84:87], v[96:99], v[36:39], v[84:87]
    v_cndmask_b32 v175, v221, v217, vcc
    s_sub_u32 s76, s77, s76
    s_sub_u32 s76, s76, 1
    s_waitcnt vmcnt(2)
    s_waitcnt lgkmcnt(0)
    ds_read_b128 v[88:91], v188 offset:256
    ds_read_b128 v[92:95], v188 offset:8448
    ds_read_b128 v[96:99], v188 offset:16640
    v_mfma_f32_16x16x32_bf16 v[64:67], v[100:103], v[40:43], v[64:67]
    v_mov_b32 v221, 0x3f80
    v_mfma_f32_16x16x32_bf16 v[68:71], v[100:103], v[44:47], v[68:71]
    s_mov_b32 s81, 0xffff0000
    s_mov_b32 s82, 0x01000100
    v_mfma_f32_16x16x32_bf16 v[72:75], v[104:107], v[40:43], v[72:75]
    v_bfe_u32 v216, v228, 9, 1
    v_mfma_f32_16x16x32_bf16 v[76:79], v[104:107], v[44:47], v[76:79]
    v_lshlrev_b32 v216, 4, v216
    v_alignbit_b32 v232, v233, v232, v216
    v_mfma_f32_16x16x32_bf16 v[80:83], v[108:111], v[40:43], v[80:83]
    v_lshrrev_b32 v233, v216, v233
    v_mfma_f32_16x16x32_bf16 v[84:87], v[108:111], v[44:47], v[84:87]
    v_lshlrev_b32 v216, 16, v232
    v_and_b32 v217, s81, v232
    s_waitcnt lgkmcnt(0)
    ds_read_b128 v[100:103], v189 offset:256
    ds_read_b128 v[104:107], v189 offset:8448
    ds_read_b128 v[108:111], v189 offset:16640
    v_mfma_f32_16x16x32_bf16 v[64:67], v[88:91], v[48:51], v[64:67]
    v_lshlrev_b32 v218, 16, v233
    v_mfma_f32_16x16x32_bf16 v[68:71], v[88:91], v[52:55], v[68:71]
    v_sub_f32 v216, v222, v216
    v_sub_f32 v217, v223, v217
    v_mfma_f32_16x16x32_bf16 v[72:75], v[92:95], v[48:51], v[72:75]
    v_sub_f32 v218, v224, v218
    v_mfma_f32_16x16x32_bf16 v[76:79], v[92:95], v[52:55], v[76:79]
    v_cvt_pk_bf16_f32 v232, v216, v217
    v_cvt_pk_bf16_f32 v233, v218, v218
    v_mfma_f32_16x16x32_bf16 v[80:83], v[96:99], v[48:51], v[80:83]
    v_lshlrev_b32 v216, 16, v232
    v_mfma_f32_16x16x32_bf16 v[84:87], v[96:99], v[52:55], v[84:87]
    v_and_b32 v217, s81, v232
    v_and_b32 v218, s81, v233
    s_waitcnt lgkmcnt(0)
    v_mfma_f32_16x16x32_bf16 v[64:67], v[100:103], v[56:59], v[64:67]
    v_mul_f32 v216, v216, v216
    v_mfma_f32_16x16x32_bf16 v[68:71], v[100:103], v[60:63], v[68:71]
    v_fmac_f32 v216, v217, v217
    v_fmac_f32 v216, v218, v218
    v_mfma_f32_16x16x32_bf16 v[72:75], v[104:107], v[56:59], v[72:75]
    v_cmp_gt_u32 vcc, 1073741824, v228
    v_mfma_f32_16x16x32_bf16 v[76:79], v[104:107], v[60:63], v[76:79]
    v_cvt_pk_bf16_f32 v236, v216, v216
    v_perm_b32 v237, v230, v230, s82
    v_mfma_f32_16x16x32_bf16 v[80:83], v[108:111], v[56:59], v[80:83]
    v_bfe_u32 v217, v230, 16, 3
    v_mfma_f32_16x16x32_bf16 v[84:87], v[108:111], v[60:63], v[84:87]
    v_lshl_add_u32 v216, v217, 4, v240
    v_lshl_add_u32 v217, v217, 1, v241
    s_mov_b64 exec, vcc
    ds_write_b16 v216, v221 offset:0
    ds_write_b16 v216, v232 offset:128
    ds_write_b16_d16_hi v216, v232 offset:256
    ds_write_b16 v216, v233 offset:384
    ds_write_b16 v217, v221 offset:0
    ds_write_b64 v242, v[236:237] offset:256
    s_mov_b64 exec, -1
    s_lshl_b32 s80, s60, 2
    s_add_u32 s80, s80, 32
    s_cmp_ge_u32 s80, s72
    s_cbranch_scc1 K2_ND1
    v_mov_b32 v221, 0x3f80
    s_mov_b32 s81, 0xffff0000
    s_mov_b32 s82, 0x01000100
    v_bfe_u32 v216, v229, 9, 1
    v_lshlrev_b32 v216, 4, v216
    v_alignbit_b32 v234, v235, v234, v216
    v_lshrrev_b32 v235, v216, v235
    v_lshlrev_b32 v216, 16, v234
    v_and_b32 v217, s81, v234
    v_lshlrev_b32 v218, 16, v235
    v_sub_f32 v216, v225, v216
    v_sub_f32 v217, v226, v217
    v_sub_f32 v218, v227, v218
    v_cvt_pk_bf16_f32 v234, v216, v217
    v_cvt_pk_bf16_f32 v235, v218, v218
    v_lshlrev_b32 v216, 16, v234
    v_and_b32 v217, s81, v234
    v_and_b32 v218, s81, v235
    v_mul_f32 v216, v216, v216
    v_fmac_f32 v216, v217, v217
    v_fmac_f32 v216, v218, v218
    v_cmp_gt_u32 vcc, 1073741824, v229
    v_cvt_pk_bf16_f32 v236, v216, v216
    v_perm_b32 v237, v231, v231, s82
    v_bfe_u32 v217, v231, 16, 3
    v_lshl_add_u32 v216, v217, 4, v240
    v_lshl_add_u32 v217, v217, 1, v241
    s_mov_b64 exec, vcc
    ds_write_b16 v216, v221 offset:32768
    ds_write_b16 v216, v234 offset:32896
    ds_write_b16_d16_hi v216, v234 offset:33024
    ds_write_b16 v216, v235 offset:33152
    ds_write_b16 v217, v221 offset:12288
    ds_write_b64 v242, v[236:237] offset:12544
    s_mov_b64 exec, -1
K2_ND1:
    s_lshl_b32 s80, s60, 9
    s_add_u32 s80, s80, 84608
    v_and_b32 v216, 15, v184
    v_lshlrev_b32 v216, 4, v216
    v_bfe_u32 v217, v184, 4, 1
    v_lshl_or_b32 v216, v217, 3, v216
    v_lshrrev_b32 v217, 5, v184
    v_lshl_or_b32 v216, v217, 12, v216
    v_add_u32 v216, s80, v216
    v_pk_mul_f32 v[64:65], v[64:65], s[84:85]
    v_pk_mul_f32 v[66:67], v[66:67], s[84:85]
    v_pk_mul_f32 v[68:69], v[68:69], s[84:85]
    v_pk_mul_f32 v[70:71], v[70:71], s[84:85]
    v_cvt_pk_bf16_f32 v88, v64, v65
    v_cvt_pk_bf16_f32 v89, v66, v67
    v_cvt_pk_bf16_f32 v90, v68, v69
    v_cvt_pk_bf16_f32 v91, v70, v71
    ds_write_b64 v216, v[88:89] offset:0
    ds_write_b64 v216, v[90:91] offset:256
    v_pk_mul_f32 v[72:73], v[72:73], s[84:85]
    v_pk_mul_f32 v[74:75], v[74:75], s[84:85]
    v_pk_mul_f32 v[76:77], v[76:77], s[84:85]
    v_pk_mul_f32 v[78:79], v[78:79], s[84:85]
    v_cvt_pk_bf16_f32 v92, v72, v73
    v_cvt_pk_bf16_f32 v93, v74, v75
    v_cvt_pk_bf16_f32 v94, v76, v77
    v_cvt_pk_bf16_f32 v95, v78, v79
    ds_write_b64 v216, v[92:93] offset:8192
    ds_write_b64 v216, v[94:95] offset:8448
    v_pk_mul_f32 v[80:81], v[80:81], s[84:85]
    v_pk_mul_f32 v[82:83], v[82:83], s[84:85]
    v_pk_mul_f32 v[84:85], v[84:85], s[84:85]
    v_pk_mul_f32 v[86:87], v[86:87], s[84:85]
    v_cvt_pk_bf16_f32 v96, v80, v81
    v_cvt_pk_bf16_f32 v97, v82, v83
    v_cvt_pk_bf16_f32 v98, v84, v85
    v_cvt_pk_bf16_f32 v99, v86, v87
    ds_write_b64 v216, v[96:97] offset:16384
    ds_write_b64 v216, v[98:99] offset:16640
    s_lshl_b32 s80, s61, 10
    s_add_u32 s80, s80, 84608
    v_add_u32 v216, s80, v201
    s_waitcnt vmcnt(2) lgkmcnt(0)
    ds_read_b128 v[104:107], v177 offset:0
    ds_read_b128 v[108:111], v179 offset:0
    ds_read2_b64 v[124:127], v173 offset0:16 offset1:24
    s_barrier
    ds_read_b128 v[128:131], v216 offset:0
    ds_read_b128 v[132:135], v216 offset:4096
    ds_read_b128 v[136:139], v216 offset:8192
    ds_read_b128 v[140:143], v216 offset:12288
    ds_read_b128 v[144:147], v216 offset:16384
K2_READY:
    ds_read_b128 v[112:115], v174 offset:0
    ds_read_b64 v[116:117], v175 offset:0
    s_waitcnt lgkmcnt(0)
    s_barrier
    s_set_gpr_idx_on s22, gpr_idx(SRC0)
    v_mov_b32 v148, v128
    v_mov_b32 v149, v129
    v_mov_b32 v150, v130
    v_mov_b32 v151, v131
    s_set_gpr_idx_off
    s_mov_b32 m0, s79
    s_cmp_lt_i32 s76, 0
    s_cbranch_scc1 K2_IDLE
    v_pk_add_f32 v[124:125], v[124:125], v[178:179] op_sel_hi:[1,0]
    v_pk_add_f32 v[126:127], v[126:127], v[178:179] op_sel_hi:[1,0]
    buffer_load_dwordx4 v124, s[24:27], s56 offen offset:0  lds
    buffer_load_dwordx4 v125, s[24:27], s57 offen offset:1024  lds
    v_mfma_f32_32x32x16_bf16 v[0:15], v[104:107], v[156:159], 0
    v_mfma_f32_32x32x16_bf16 v[0:15], v[108:111], v[160:163], v[0:15]
    v_mfma_f32_32x32x16_bf16 v[0:15], v[112:115], v[148:151], v[0:15]
    v_mfma_f32_32x32x8_bf16 v[0:15], v[116:117], v[152:153], v[0:15]
    s_waitcnt vmcnt(2)
    ds_read_b128 v[104:107], v177 offset:2048
    ds_read_b128 v[108:111], v179 offset:2048
    ds_read_b128 v[112:115], v174 offset:384
    ds_read_b64 v[116:117], v175 offset:384
    v_add_u32 v174, v176, v174
    v_add_u32 v175, v176, v175
.p2align 6
K2_LOOP:
    s_setprio 0
    s_waitcnt lgkmcnt(0)
    s_and_b32 s80, s74, 5
    s_cbranch_scc1 K2_H2
K2_R2:
    v_mfma_f32_32x32x16_bf16 v[16:31], v[104:107], v[156:159], 0
    v_cvt_pk_bf16_f32 v96, v48, v49
    v_cvt_pk_bf16_f32 v97, v50, v51
    buffer_load_dwordx4 v126, s[24:27], s58 offen offset:2048  lds
    v_cvt_pk_bf16_f32 v98, v52, v53
    v_cvt_pk_bf16_f32 v99, v54, v55
    buffer_load_dwordx4 v127, s[24:27], 0 offen offset:3072  lds
    v_cvt_pk_bf16_f32 v100, v56, v57
    v_cvt_pk_bf16_f32 v101, v58, v59
    v_mfma_f32_32x32x16_bf16 v[16:31], v[108:111], v[160:163], v[16:31]
    v_cvt_pk_bf16_f32 v102, v60, v61
    v_cvt_pk_bf16_f32 v103, v62, v63
    v_exp_f32 v32, -v0
    v_exp_f32 v33, -v1
    v_mfma_f32_32x32x16_bf16 v[16:31], v[112:115], v[148:151], v[16:31]
    v_exp_f32 v34, -v2
    v_exp_f32 v35, -v3
    v_exp_f32 v36, -v4
    v_mfma_f32_32x32x8_bf16 v[16:31], v[116:117], v[152:153], v[16:31]
    v_exp_f32 v37, -v5
    v_exp_f32 v38, -v6
    v_exp_f32 v39, -v7
    v_mfma_f32_32x32x16_bf16 v[64:79], v[96:99], v[120:123], v[64:79]
    v_exp_f32 v40, -v8
    v_exp_f32 v41, -v9
    v_exp_f32 v42, -v10
    v_mfma_f32_32x32x16_bf16 v[80:95], v[100:103], v[120:123], v[80:95]
    v_exp_f32 v43, -v11
    ds_read_b128 v[120:123], v172
    ds_read2_b64 v[124:127], v173 offset0:32 offset1:40
    v_exp_f32 v44, -v12
    v_exp_f32 v45, -v13
    v_exp_f32 v46, -v14
    v_exp_f32 v47, -v15
    v_exp_f32 v48, -v16
    v_exp_f32 v49, -v17
    v_mfma_f32_32x32x8_bf16 v[32:47], v[164:165], v[164:165], v[32:47]
    v_exp_f32 v50, -v18
    v_exp_f32 v51, -v19
    v_exp_f32 v52, -v20
    v_exp_f32 v53, -v21
    v_exp_f32 v54, -v22
    v_exp_f32 v55, -v23
    v_exp_f32 v56, -v24
    v_exp_f32 v57, -v25
    v_exp_f32 v58, -v26
    v_exp_f32 v59, -v27
    v_exp_f32 v60, -v28
    v_exp_f32 v61, -v29
    v_exp_f32 v62, -v30
    v_exp_f32 v63, -v31
    v_rcp_f32 v32, v32
    v_rcp_f32 v33, v33
    v_mfma_f32_32x32x8_bf16 v[48:63], v[164:165], v[164:165], v[48:63]
    v_rcp_f32 v34, v34
    v_rcp_f32 v35, v35
    v_rcp_f32 v36, v36
    v_rcp_f32 v37, v37
    v_rcp_f32 v38, v38
    s_waitcnt vmcnt(2) lgkmcnt(0)
    ds_read_b128 v[104:107], v177 offset:0
    ds_read_b128 v[108:111], v179 offset:0
    ds_read_b128 v[112:115], v174 offset:0
    ds_read_b64 v[116:117], v175 offset:0
    v_rcp_f32 v39, v39
    v_rcp_f32 v40, v40
    v_rcp_f32 v41, v41
    v_rcp_f32 v42, v42
    s_setprio 3
    v_rcp_f32 v43, v43
    v_rcp_f32 v44, v44
    v_rcp_f32 v45, v45
    v_rcp_f32 v46, v46
    v_rcp_f32 v47, v47
    v_pk_mul_f32 v[32:33], v[32:33], v[0:1]
    v_pk_mul_f32 v[34:35], v[34:35], v[2:3]
    v_pk_mul_f32 v[36:37], v[36:37], v[4:5]
    v_pk_mul_f32 v[38:39], v[38:39], v[6:7]
    v_pk_mul_f32 v[40:41], v[40:41], v[8:9]
    v_pk_mul_f32 v[42:43], v[42:43], v[10:11]
    v_pk_mul_f32 v[44:45], v[44:45], v[12:13]
    v_pk_mul_f32 v[46:47], v[46:47], v[14:15]
    v_pk_add_f32 v[124:125], v[124:125], v[178:179] op_sel_hi:[1,0]
    v_pk_add_f32 v[126:127], v[126:127], v[178:179] op_sel_hi:[1,0]
    s_setprio 0
    s_waitcnt lgkmcnt(0)
    s_and_b32 s80, s74, 10
    s_cbranch_scc1 K2_H4
K2_R4:
    v_mfma_f32_32x32x16_bf16 v[0:15], v[104:107], v[156:159], 0
    v_cvt_pk_bf16_f32 v96, v32, v33
    v_cvt_pk_bf16_f32 v97, v34, v35
    buffer_load_dwordx4 v124, s[24:27], s56 offen offset:0  lds
    v_cvt_pk_bf16_f32 v98, v36, v37
    v_cvt_pk_bf16_f32 v99, v38, v39
    buffer_load_dwordx4 v125, s[24:27], s57 offen offset:1024  lds
    v_cvt_pk_bf16_f32 v100, v40, v41
    v_cvt_pk_bf16_f32 v101, v42, v43
    v_mfma_f32_32x32x16_bf16 v[0:15], v[108:111], v[160:163], v[0:15]
    v_cvt_pk_bf16_f32 v102, v44, v45
    v_cvt_pk_bf16_f32 v103, v46, v47
    v_rcp_f32 v48, v48
    v_rcp_f32 v49, v49
    v_mfma_f32_32x32x16_bf16 v[0:15], v[112:115], v[148:151], v[0:15]
    v_rcp_f32 v50, v50
    v_rcp_f32 v51, v51
    v_rcp_f32 v52, v52
    v_mfma_f32_32x32x8_bf16 v[0:15], v[116:117], v[152:153], v[0:15]
    v_rcp_f32 v53, v53
    s_waitcnt vmcnt(2)
    ds_read_b128 v[104:107], v177 offset:2048
    ds_read_b128 v[108:111], v179 offset:2048
    ds_read_b128 v[112:115], v174 offset:384
    ds_read_b64 v[116:117], v175 offset:384
    v_rcp_f32 v54, v54
    v_rcp_f32 v55, v55
    v_mfma_f32_32x32x16_bf16 v[64:79], v[96:99], v[120:123], v[64:79]
    v_rcp_f32 v56, v56
    s_lshr_b64 s[74:75], s[74:75], 2
    s_sub_u32 s76, s76, 1
    v_rcp_f32 v57, v57
    v_rcp_f32 v58, v58
    v_mfma_f32_32x32x16_bf16 v[80:95], v[100:103], v[120:123], v[80:95]
    v_rcp_f32 v59, v59
    ds_read_b128 v[120:123], v172 offset:1024
    s_setprio 3
    v_rcp_f32 v60, v60
    v_rcp_f32 v61, v61
    v_rcp_f32 v62, v62
    v_rcp_f32 v63, v63
    v_pk_mul_f32 v[48:49], v[48:49], v[16:17]
    v_pk_mul_f32 v[50:51], v[50:51], v[18:19]
    v_pk_mul_f32 v[52:53], v[52:53], v[20:21]
    v_pk_mul_f32 v[54:55], v[54:55], v[22:23]
    v_pk_mul_f32 v[56:57], v[56:57], v[24:25]
    v_pk_mul_f32 v[58:59], v[58:59], v[26:27]
    v_pk_mul_f32 v[60:61], v[60:61], v[28:29]
    v_pk_mul_f32 v[62:63], v[62:63], v[30:31]
    v_pk_add_f32 v[172:173], v[172:173], s[100:101]
    v_pk_add_f32 v[174:175], v[174:175], v[176:177] op_sel_hi:[1,0]
    s_cbranch_scc0 K2_LOOP
    s_setprio 0
    s_waitcnt lgkmcnt(0)
    s_and_b32 s80, s74, 1
    s_cbranch_scc1 K2_H6
K2_R6:
    v_cvt_pk_bf16_f32 v96, v48, v49
    v_cvt_pk_bf16_f32 v97, v50, v51
    v_cvt_pk_bf16_f32 v98, v52, v53
    v_cvt_pk_bf16_f32 v99, v54, v55
    v_cvt_pk_bf16_f32 v100, v56, v57
    v_cvt_pk_bf16_f32 v101, v58, v59
    v_cvt_pk_bf16_f32 v102, v60, v61
    v_cvt_pk_bf16_f32 v103, v62, v63
    v_and_b32 v104, 15, v184
    v_and_b32 v106, 48, v184
    v_mfma_f32_32x32x16_bf16 v[64:79], v[96:99], v[120:123], v[64:79]
    v_mfma_f32_32x32x16_bf16 v[80:95], v[100:103], v[120:123], v[80:95]
    v_mul_u32_u24 v107, 528, v104
    v_add_u32 v107, v107, v106
    v_lshrrev_b32 v105, 3, v104
    v_lshrrev_b32 v105, v105, s23
    v_mov_b32 v108, 80128
    v_and_b32 v109, 1, v105
    v_cmp_ne_u32 vcc, 0, v109
    v_add_u32 v110, 84608, v107
    s_nop 0
    v_cndmask_b32 v173, v108, v110, vcc
    s_cmp_lg_u32 s64, 0
    s_cbranch_scc1 K2_FA8
K2_FB8:
    ds_read_b128 v[32:35], v181 offset:0
    ds_read_b128 v[36:39], v181 offset:32
    ds_read_b128 v[40:43], v181 offset:64
    ds_read_b128 v[44:47], v181 offset:96
    s_mul_i32 s80, s78, 1056
    s_lshl_b32 s81, s78, 7
    s_add_u32 s81, s81, s20
    v_cvt_pk_bf16_f32 v16, v64, v65
    v_cvt_pk_bf16_f32 v17, v66, v67
    v_cvt_pk_bf16_f32 v18, v68, v69
    v_cvt_pk_bf16_f32 v19, v70, v71
    v_cvt_pk_bf16_f32 v20, v72, v73
    v_cvt_pk_bf16_f32 v21, v74, v75
    v_cvt_pk_bf16_f32 v22, v76, v77
    v_cvt_pk_bf16_f32 v23, v78, v79
    v_add_u32 v182, s80, v180
    v_lshl_add_u32 v183, v184, 2, s81
    v_cvt_pk_bf16_f32 v24, v80, v81
    v_cvt_pk_bf16_f32 v25, v82, v83
    v_cvt_pk_bf16_f32 v26, v84, v85
    v_cvt_pk_bf16_f32 v27, v86, v87
    v_cvt_pk_bf16_f32 v28, v88, v89
    v_cvt_pk_bf16_f32 v29, v90, v91
    v_cvt_pk_bf16_f32 v30, v92, v93
    v_cvt_pk_bf16_f32 v31, v94, v95
    s_waitcnt lgkmcnt(0)
    s_mov_b64 exec, s[90:91]
    v_mfma_f32_32x32x16_bf16 v[80:95], v[32:35], v[16:19], 0
    ds_write_b64 v182, v[16:17] offset:0
    ds_write_b64 v182, v[18:19] offset:16
    ds_write_b64 v182, v[20:21] offset:32
    v_mfma_f32_32x32x16_bf16 v[80:95], v[36:39], v[20:23], v[80:95]
    ds_write_b64 v182, v[22:23] offset:48
    ds_write_b64 v182, v[24:25] offset:64
    ds_write_b64 v182, v[26:27] offset:80
    v_mfma_f32_32x32x16_bf16 v[80:95], v[40:43], v[24:27], v[80:95]
    ds_write_b64 v182, v[28:29] offset:96
    ds_write_b64 v182, v[30:31] offset:112
    s_mov_b64 exec, -1
    v_mfma_f32_32x32x16_bf16 v[80:95], v[44:47], v[28:31], v[80:95]
    v_and_b32 v109, 4, v105
    v_cmp_ne_u32 vcc, 0, v109
    v_add_u32 v110, 93056, v107
    s_nop 0
    v_cndmask_b32 v174, v108, v110, vcc
    v_and_b32 v109, 16, v105
    v_cmp_ne_u32 vcc, 0, v109
    v_add_u32 v110, 101504, v107
    s_nop 0
    v_cndmask_b32 v175, v108, v110, vcc
    s_nop 1
    v_add_f32 v182, v190, v80
    s_mov_b32 exec_hi, 0
    ds_write_b32 v183, v182
    s_mov_b32 exec_hi, -1
K2_DONE:
    s_cmp_lg_u32 s64, 0
    s_cbranch_scc1 K2_NEXT
K2_FINAL:
    s_cmp_ge_u32 s59, 4
    s_cbranch_scc0 K2_WREST
    s_sub_u32 s52, s86, 131072
    s_add_u32 s53, s52, 4096
    s_add_u32 s54, s52, 8192
    s_add_u32 s55, s52, 12288
    s_waitcnt lgkmcnt(0)
    buffer_load_dwordx4 v[64:67], v191, s[36:39], s52 offen offset:0
    buffer_load_dwordx4 v[68:71], v191, s[36:39], s52 offen offset:1024
    buffer_load_dwordx4 v[72:75], v191, s[36:39], s52 offen offset:2048
    buffer_load_dwordx4 v[76:79], v191, s[36:39], s52 offen offset:3072
    s_lshl_b32 s80, s60, 6
    s_and_b32 s81, s80, 192
    s_and_b32 s82, s80, 256
    v_xor_b32 v179, s81, v186
    v_add_u32 v179, s82, v179
    ds_read_b128 v[48:51], v179 offset:0
    ds_read_b128 v[52:55], v179 offset:8192
    ds_read_b128 v[56:59], v179 offset:16384
    s_barrier
    ds_read_b128 v[128:131], v173 offset:0
    ds_read_b128 v[132:135], v174 offset:0
    ds_read_b128 v[136:139], v175 offset:0
    ds_read_b128 v[140:143], v173 offset:64
    ds_read_b128 v[144:147], v174 offset:64
    ds_read_b128 v[148:151], v175 offset:64
    s_waitcnt vmcnt(4) lgkmcnt(3)
    ds_read_b128 v[152:155], v173 offset:128
    ds_read_b128 v[156:159], v174 offset:128
    ds_read_b128 v[160:163], v175 offset:128
    v_mfma_f32_16x16x32_bf16 v[0:3], v[192:195], v[128:131], 0
    v_and_b32 v24, 15, v184
    v_mfma_f32_16x16x32_bf16 v[4:7], v[224:227], v[128:131], 0
    v_and_b32 v26, 48, v184
    v_mfma_f32_16x16x32_bf16 v[8:11], v[192:195], v[132:135], 0
    s_lshl_b32 s80, s60, 6
    v_mfma_f32_16x16x32_bf16 v[12:15], v[224:227], v[132:135], 0
    s_mul_i32 s81, s2, 20480
    v_mfma_f32_16x16x32_bf16 v[16:19], v[192:195], v[136:139], 0
    s_add_u32 s23, s80, s81
    v_mfma_f32_16x16x32_bf16 v[20:23], v[224:227], v[136:139], 0
    buffer_load_dwordx4 v[80:83], v191, s[36:39], s53 offen offset:0
    buffer_load_dwordx4 v[84:87], v191, s[36:39], s53 offen offset:1024
    s_waitcnt lgkmcnt(3)
    ds_read_b128 v[128:131], v173 offset:192
    ds_read_b128 v[132:135], v174 offset:192
    ds_read_b128 v[136:139], v175 offset:192
    v_mfma_f32_16x16x32_bf16 v[0:3], v[196:199], v[140:143], v[0:3]
    v_bfe_u32 v25, v184, 1, 2
    v_mfma_f32_16x16x32_bf16 v[4:7], v[228:231], v[140:143], v[4:7]
    v_lshlrev_b32 v25, 4, v25
    v_mfma_f32_16x16x32_bf16 v[8:11], v[196:199], v[144:147], v[8:11]
    v_xor_b32 v25, v25, v26
    v_mfma_f32_16x16x32_bf16 v[12:15], v[228:231], v[144:147], v[12:15]
    v_lshl_or_b32 v25, v24, 6, v25
    v_mfma_f32_16x16x32_bf16 v[16:19], v[196:199], v[148:151], v[16:19]
    v_add_u32 v177, s79, v25
    v_mfma_f32_16x16x32_bf16 v[20:23], v[228:231], v[148:151], v[20:23]
    buffer_load_dwordx4 v[88:91], v191, s[36:39], s53 offen offset:2048
    buffer_load_dwordx4 v[92:95], v191, s[36:39], s53 offen offset:3072
    s_waitcnt lgkmcnt(3)
    ds_read_b128 v[140:143], v173 offset:256
    ds_read_b128 v[144:147], v174 offset:256
    ds_read_b128 v[148:151], v175 offset:256
    v_mfma_f32_16x16x32_bf16 v[0:3], v[200:203], v[152:155], v[0:3]
    v_bfe_u32 v25, v184, 3, 2
    v_mfma_f32_16x16x32_bf16 v[4:7], v[232:235], v[152:155], v[4:7]
    v_xor_b32 v25, v25, v184
    v_mfma_f32_16x16x32_bf16 v[8:11], v[200:203], v[156:159], v[8:11]
    v_lshl_add_u32 v178, v25, 4, s79
    v_mfma_f32_16x16x32_bf16 v[12:15], v[232:235], v[156:159], v[12:15]
    v_lshrrev_b32 v25, 2, v184
    v_mfma_f32_16x16x32_bf16 v[16:19], v[200:203], v[160:163], v[16:19]
    v_and_b32 v27, 3, v184
    v_mfma_f32_16x16x32_bf16 v[20:23], v[232:235], v[160:163], v[20:23]
    buffer_load_dwordx4 v[96:99], v191, s[36:39], s54 offen offset:0
    buffer_load_dwordx4 v[100:103], v191, s[36:39], s54 offen offset:1024
    s_waitcnt lgkmcnt(3)
    ds_read_b128 v[152:155], v173 offset:320
    ds_read_b128 v[156:159], v174 offset:320
    ds_read_b128 v[160:163], v175 offset:320
    v_mfma_f32_16x16x32_bf16 v[0:3], v[204:207], v[128:131], v[0:3]
    v_lshlrev_b32 v27, 4, v27
    v_mfma_f32_16x16x32_bf16 v[4:7], v[236:239], v[128:131], v[4:7]
    v_lshl_or_b32 v176, v25, 9, v27
    v_mfma_f32_16x16x32_bf16 v[8:11], v[204:207], v[132:135], v[8:11]
    s_mov_b32 s90, 0x00ff00ff
    v_mfma_f32_16x16x32_bf16 v[12:15], v[236:239], v[132:135], v[12:15]
    s_bitcmp1_b32 s21, 0
    v_mfma_f32_16x16x32_bf16 v[16:19], v[204:207], v[136:139], v[16:19]
    s_cselect_b32 s90, 0xff00ff00, s90
    v_mfma_f32_16x16x32_bf16 v[20:23], v[236:239], v[136:139], v[20:23]
    buffer_load_dwordx4 v[104:107], v191, s[36:39], s54 offen offset:2048
    buffer_load_dwordx4 v[108:111], v191, s[36:39], s54 offen offset:3072
    s_waitcnt lgkmcnt(3)
    ds_read_b128 v[128:131], v173 offset:384
    ds_read_b128 v[132:135], v174 offset:384
    ds_read_b128 v[136:139], v175 offset:384
    v_mfma_f32_16x16x32_bf16 v[0:3], v[208:211], v[140:143], v[0:3]
    s_mov_b32 s91, s90
    v_mfma_f32_16x16x32_bf16 v[4:7], v[240:243], v[140:143], v[4:7]
    s_mov_b32 s84, 1069066811
    v_mfma_f32_16x16x32_bf16 v[8:11], v[208:211], v[144:147], v[8:11]
    s_mov_b32 s85, 1069066811
    v_mfma_f32_16x16x32_bf16 v[12:15], v[240:243], v[144:147], v[12:15]
    s_mov_b32 s92, 1060205080
    v_mfma_f32_16x16x32_bf16 v[16:19], v[208:211], v[148:151], v[16:19]
    s_mov_b32 s93, 1060205080
    v_mfma_f32_16x16x32_bf16 v[20:23], v[240:243], v[148:151], v[20:23]
    buffer_load_dwordx4 v[112:115], v191, s[36:39], s55 offen offset:0
    s_waitcnt lgkmcnt(3)
    ds_read_b128 v[140:143], v173 offset:448
    ds_read_b128 v[144:147], v174 offset:448
    ds_read_b128 v[148:151], v175 offset:448
    v_mfma_f32_16x16x32_bf16 v[0:3], v[212:215], v[152:155], v[0:3]
    v_mfma_f32_16x16x32_bf16 v[4:7], v[244:247], v[152:155], v[4:7]
    v_mfma_f32_16x16x32_bf16 v[8:11], v[212:215], v[156:159], v[8:11]
    s_mov_b32 s81, 0xffff0000
    v_mfma_f32_16x16x32_bf16 v[12:15], v[244:247], v[156:159], v[12:15]
    v_mfma_f32_16x16x32_bf16 v[16:19], v[212:215], v[160:163], v[16:19]
    v_mfma_f32_16x16x32_bf16 v[20:23], v[244:247], v[160:163], v[20:23]
    buffer_load_dwordx4 v[116:119], v191, s[36:39], s55 offen offset:1024
    s_waitcnt lgkmcnt(3)
    ds_read_b128 v[152:155], v186 offset:0
    ds_read_b128 v[156:159], v186 offset:8192
    ds_read_b128 v[160:163], v186 offset:16384
    v_mfma_f32_16x16x32_bf16 v[0:3], v[216:219], v[128:131], v[0:3]
    v_mfma_f32_16x16x32_bf16 v[4:7], v[248:251], v[128:131], v[4:7]
    v_mfma_f32_16x16x32_bf16 v[8:11], v[216:219], v[132:135], v[8:11]
    v_mfma_f32_16x16x32_bf16 v[12:15], v[248:251], v[132:135], v[12:15]
    v_mfma_f32_16x16x32_bf16 v[16:19], v[216:219], v[136:139], v[16:19]
    v_mfma_f32_16x16x32_bf16 v[20:23], v[248:251], v[136:139], v[20:23]
    buffer_load_dwordx4 v[120:123], v191, s[36:39], s55 offen offset:2048
    s_waitcnt lgkmcnt(3)
    ds_read_b128 v[128:131], v187 offset:0
    ds_read_b128 v[132:135], v187 offset:8192
    ds_read_b128 v[136:139], v187 offset:16384
    v_mfma_f32_16x16x32_bf16 v[0:3], v[220:223], v[140:143], v[0:3]
    v_mfma_f32_16x16x32_bf16 v[4:7], v[252:255], v[140:143], v[4:7]
    v_mfma_f32_16x16x32_bf16 v[8:11], v[220:223], v[144:147], v[8:11]
    v_mfma_f32_16x16x32_bf16 v[12:15], v[252:255], v[144:147], v[12:15]
    v_mfma_f32_16x16x32_bf16 v[16:19], v[220:223], v[148:151], v[16:19]
    v_mfma_f32_16x16x32_bf16 v[20:23], v[252:255], v[148:151], v[20:23]
    buffer_load_dwordx4 v[124:127], v191, s[36:39], s55 offen offset:3072
    s_waitcnt vmcnt(8) lgkmcnt(3)
    ds_read_b128 v[140:143], v188 offset:0
    ds_read_b128 v[144:147], v188 offset:8192
    ds_read_b128 v[148:151], v188 offset:16384
    v_mfma_f32_16x16x32_bf16 v[24:27], v[64:67], v[152:155], 0
    v_mfma_f32_16x16x32_bf16 v[32:35], v[64:67], v[156:159], 0
    v_mfma_f32_16x16x32_bf16 v[40:43], v[64:67], v[160:163], 0
    s_waitcnt lgkmcnt(3)
    ds_read_b128 v[152:155], v189 offset:0
    ds_read_b128 v[156:159], v189 offset:8192
    ds_read_b128 v[160:163], v189 offset:16384
    v_mfma_f32_16x16x32_bf16 v[24:27], v[68:71], v[128:131], v[24:27]
    v_mfma_f32_16x16x32_bf16 v[32:35], v[68:71], v[132:135], v[32:35]
    v_mfma_f32_16x16x32_bf16 v[40:43], v[68:71], v[136:139], v[40:43]
    s_waitcnt lgkmcnt(3)
    ds_read_b128 v[128:131], v186 offset:256
    ds_read_b128 v[132:135], v186 offset:8448
    ds_read_b128 v[136:139], v186 offset:16640
    v_mfma_f32_16x16x32_bf16 v[24:27], v[72:75], v[140:143], v[24:27]
    v_mfma_f32_16x16x32_bf16 v[32:35], v[72:75], v[144:147], v[32:35]
    v_mfma_f32_16x16x32_bf16 v[40:43], v[72:75], v[148:151], v[40:43]
    s_bitcmp1_b32 s21, 0
    s_cbranch_scc1 K2_XO9
    v_mov_b32_dpp v60, v16 row_ror:8 row_mask:0xf bank_mask:0xf
    v_mov_b32_dpp v61, v17 row_ror:8 row_mask:0xf bank_mask:0xf
    v_mov_b32_dpp v62, v18 row_ror:8 row_mask:0xf bank_mask:0xf
    v_mov_b32_dpp v63, v19 row_ror:8 row_mask:0xf bank_mask:0xf
K2_XD9:
    s_lshr_b32 s80, s21, 1
    s_lshl_b32 s80, s80, 3
    s_mov_b64 exec, s[90:91]
    s_set_gpr_idx_on s80, gpr_idx(SRC1,DST)
    v_add_f32 v0, v60, v0
    v_add_f32 v1, v61, v1
    v_add_f32 v2, v62, v2
    v_add_f32 v3, v63, v3
    s_set_gpr_idx_off
    s_mov_b64 exec, -1
    s_waitcnt lgkmcnt(3)
    ds_read_b128 v[140:143], v187 offset:256
    ds_read_b128 v[144:147], v187 offset:8448
    ds_read_b128 v[148:151], v187 offset:16640
    v_mfma_f32_16x16x32_bf16 v[24:27], v[76:79], v[152:155], v[24:27]
    v_mfma_f32_16x16x32_bf16 v[32:35], v[76:79], v[156:159], v[32:35]
    v_mfma_f32_16x16x32_bf16 v[40:43], v[76:79], v[160:163], v[40:43]
    s_bitcmp1_b32 s21, 0
    s_cbranch_scc1 K2_XO10
    v_mov_b32_dpp v60, v20 row_ror:8 row_mask:0xf bank_mask:0xf
    v_mov_b32_dpp v61, v21 row_ror:8 row_mask:0xf bank_mask:0xf
    v_mov_b32_dpp v62, v22 row_ror:8 row_mask:0xf bank_mask:0xf
    v_mov_b32_dpp v63, v23 row_ror:8 row_mask:0xf bank_mask:0xf
K2_XD10:
    s_lshr_b32 s80, s21, 1
    s_lshl_b32 s80, s80, 3
    s_mov_b64 exec, s[90:91]
    s_set_gpr_idx_on s80, gpr_idx(SRC1,DST)
    v_add_f32 v4, v60, v4
    v_add_f32 v5, v61, v5
    v_add_f32 v6, v62, v6
    v_add_f32 v7, v63, v7
    s_set_gpr_idx_off
    s_mov_b64 exec, -1
    s_waitcnt lgkmcnt(3)
    ds_read_b128 v[152:155], v188 offset:256
    ds_read_b128 v[156:159], v188 offset:8448
    ds_read_b128 v[160:163], v188 offset:16640
    v_mfma_f32_16x16x32_bf16 v[24:27], v[80:83], v[128:131], v[24:27]
    v_mfma_f32_16x16x32_bf16 v[32:35], v[80:83], v[132:135], v[32:35]
    v_mfma_f32_16x16x32_bf16 v[40:43], v[80:83], v[136:139], v[40:43]
    s_cmp_ge_u32 s60, 2
    s_cbranch_scc1 K2_NOPOS
    v_mul_u32_u24 v63, 21846, v185
    v_lshrrev_b32 v63, 16, v63
    v_mul_u32_u24 v180, 3, v63
    v_sub_u32 v180, v185, v180
    v_and_b32 v181, 7, v63
    v_lshl_add_u32 v180, v180, 3, v181
    v_lshlrev_b32 v180, 2, v180
    v_add_u32 v180, 80672, v180
    v_lshrrev_b32 v63, 3, v63
    v_lshl_add_u32 v181, v63, 9, v180
    v_add_u32 v180, 2560, v180
    ds_read2_b32 v[164:165], v181 offset1:32
    ds_read2_b32 v[166:167], v181 offset0:64 offset1:96
    ds_read2_b32 v[168:169], v180 offset1:32
    ds_read2_b32 v[170:171], v180 offset0:64 offset1:96
    v_lshlrev_b32 v61, 1, v185
    v_add_u32 v182, 84352, v61
    ds_read_u16 v62, v182
    v_cmp_gt_u32 vcc, 120, v185
    s_mul_i32 s88, s2, 240
    s_add_u32 s88, s88, 5120000
    v_mov_b32 v60, 1073741824
    v_cndmask_b32 v60, v60, v61, vcc
    v_cmp_eq_u32 vcc, s21, v63
    s_waitcnt lgkmcnt(0)
    v_pk_add_f32 v[164:165], v[164:165], v[166:167]
    v_pk_add_f32 v[168:169], v[168:169], v[170:171]
    v_lshlrev_b32 v62, 16, v62
    v_add_f32 v164, v164, v165
    v_add_f32 v168, v168, v169
    v_cndmask_b32 v168, 0, v168, vcc
    v_add_f32 v164, v164, v168
    v_fma_f32 v62, v164, s92, v62
    v_cvt_pk_bf16_f32 v62, v62, v62
K2_NOPOS:
    s_waitcnt lgkmcnt(3)
    ds_read_b128 v[128:131], v189 offset:256
    ds_read_b128 v[132:135], v189 offset:8448
    ds_read_b128 v[136:139], v189 offset:16640
    v_mfma_f32_16x16x32_bf16 v[24:27], v[84:87], v[140:143], v[24:27]
    v_mfma_f32_16x16x32_bf16 v[32:35], v[84:87], v[144:147], v[32:35]
    v_mfma_f32_16x16x32_bf16 v[40:43], v[84:87], v[148:151], v[40:43]
    s_waitcnt lgkmcnt(3)
    ds_read_b128 v[140:143], v186 offset:0
    ds_read_b128 v[144:147], v186 offset:8192
    ds_read_b128 v[148:151], v186 offset:16384
    v_mfma_f32_16x16x32_bf16 v[24:27], v[88:91], v[152:155], v[24:27]
    v_mfma_f32_16x16x32_bf16 v[32:35], v[88:91], v[156:159], v[32:35]
    v_mfma_f32_16x16x32_bf16 v[40:43], v[88:91], v[160:163], v[40:43]
    s_waitcnt lgkmcnt(3)
    ds_read_b128 v[152:155], v187 offset:0
    ds_read_b128 v[156:159], v187 offset:8192
    ds_read_b128 v[160:163], v187 offset:16384
    v_mfma_f32_16x16x32_bf16 v[24:27], v[92:95], v[128:131], v[24:27]
    v_mfma_f32_16x16x32_bf16 v[32:35], v[92:95], v[132:135], v[32:35]
    v_mfma_f32_16x16x32_bf16 v[40:43], v[92:95], v[136:139], v[40:43]
    s_waitcnt vmcnt(7) lgkmcnt(3)
    ds_read_b128 v[128:131], v188 offset:0
    ds_read_b128 v[132:135], v188 offset:8192
    ds_read_b128 v[136:139], v188 offset:16384
    v_mfma_f32_16x16x32_bf16 v[28:31], v[96:99], v[140:143], 0
    v_mfma_f32_16x16x32_bf16 v[36:39], v[96:99], v[144:147], 0
    v_mfma_f32_16x16x32_bf16 v[44:47], v[96:99], v[148:151], 0
    s_nop 0
    v_fmac_f32 v0, s84, v24
    v_fmac_f32 v1, s84, v25
    v_fmac_f32 v2, s84, v26
    s_waitcnt vmcnt(6) lgkmcnt(3)
    ds_read_b128 v[140:143], v189 offset:0
    ds_read_b128 v[144:147], v189 offset:8192
    ds_read_b128 v[148:151], v189 offset:16384
    v_mfma_f32_16x16x32_bf16 v[28:31], v[100:103], v[152:155], v[28:31]
    v_mfma_f32_16x16x32_bf16 v[36:39], v[100:103], v[156:159], v[36:39]
    v_mfma_f32_16x16x32_bf16 v[44:47], v[100:103], v[160:163], v[44:47]
    v_fmac_f32 v3, s84, v27
    v_fmac_f32 v8, s84, v32
    v_fmac_f32 v9, s84, v33
    v_fmac_f32 v10, s84, v34
    v_fmac_f32 v11, s84, v35
    v_fmac_f32 v16, s84, v40
    v_fmac_f32 v17, s84, v41
    v_fmac_f32 v18, s84, v42
    v_fmac_f32 v19, s84, v43
    s_waitcnt vmcnt(5) lgkmcnt(3)
    ds_read_b128 v[152:155], v186 offset:256
    ds_read_b128 v[156:159], v186 offset:8448
    ds_read_b128 v[160:163], v186 offset:16640
    v_mfma_f32_16x16x32_bf16 v[28:31], v[104:107], v[128:131], v[28:31]
    v_mfma_f32_16x16x32_bf16 v[36:39], v[104:107], v[132:135], v[36:39]
    v_mfma_f32_16x16x32_bf16 v[44:47], v[104:107], v[136:139], v[44:47]
    v_exp_f32 v164, -v0
    v_exp_f32 v165, -v1
    v_exp_f32 v166, -v2
    v_exp_f32 v167, -v3
    v_exp_f32 v168, -v8
    v_exp_f32 v169, -v9
    v_exp_f32 v170, -v10
    v_exp_f32 v171, -v11
    v_exp_f32 v180, -v16
    s_waitcnt vmcnt(4) lgkmcnt(3)
    ds_read_b128 v[128:131], v187 offset:256
    ds_read_b128 v[132:135], v187 offset:8448
    ds_read_b128 v[136:139], v187 offset:16640
    v_mfma_f32_16x16x32_bf16 v[28:31], v[108:111], v[140:143], v[28:31]
    v_mfma_f32_16x16x32_bf16 v[36:39], v[108:111], v[144:147], v[36:39]
    v_mfma_f32_16x16x32_bf16 v[44:47], v[108:111], v[148:151], v[44:47]
    v_exp_f32 v181, -v17
    v_exp_f32 v182, -v18
    v_exp_f32 v183, -v19
    v_add_f32 v164, 1.0, v164
    v_add_f32 v165, 1.0, v165
    v_add_f32 v166, 1.0, v166
    v_add_f32 v167, 1.0, v167
    v_add_f32 v168, 1.0, v168
    v_add_f32 v169, 1.0, v169
    s_waitcnt vmcnt(3) lgkmcnt(3)
    ds_read_b128 v[140:143], v188 offset:256
    ds_read_b128 v[144:147], v188 offset:8448
    ds_read_b128 v[148:151], v188 offset:16640
    v_mfma_f32_16x16x32_bf16 v[28:31], v[112:115], v[152:155], v[28:31]
    v_mfma_f32_16x16x32_bf16 v[36:39], v[112:115], v[156:159], v[36:39]
    v_mfma_f32_16x16x32_bf16 v[44:47], v[112:115], v[160:163], v[44:47]
    v_add_f32 v170, 1.0, v170
    v_add_f32 v171, 1.0, v171
    v_add_f32 v180, 1.0, v180
    v_add_f32 v181, 1.0, v181
    v_add_f32 v182, 1.0, v182
    v_add_f32 v183, 1.0, v183
    v_rcp_f32 v164, v164
    v_rcp_f32 v165, v165
    v_rcp_f32 v166, v166
    s_waitcnt vmcnt(2) lgkmcnt(3)
    ds_read_b128 v[152:155], v189 offset:256
    ds_read_b128 v[156:159], v189 offset:8448
    ds_read_b128 v[160:163], v189 offset:16640
    v_mfma_f32_16x16x32_bf16 v[28:31], v[116:119], v[128:131], v[28:31]
    v_mfma_f32_16x16x32_bf16 v[36:39], v[116:119], v[132:135], v[36:39]
    v_mfma_f32_16x16x32_bf16 v[44:47], v[116:119], v[136:139], v[44:47]
    v_rcp_f32 v167, v167
    v_rcp_f32 v168, v168
    v_rcp_f32 v169, v169
    v_rcp_f32 v170, v170
    v_rcp_f32 v171, v171
    v_rcp_f32 v180, v180
    v_rcp_f32 v181, v181
    v_rcp_f32 v182, v182
    v_rcp_f32 v183, v183
    s_waitcnt vmcnt(1) lgkmcnt(3)
    v_mfma_f32_16x16x32_bf16 v[28:31], v[120:123], v[140:143], v[28:31]
    v_mfma_f32_16x16x32_bf16 v[36:39], v[120:123], v[144:147], v[36:39]
    v_mfma_f32_16x16x32_bf16 v[44:47], v[120:123], v[148:151], v[44:47]
    v_mul_f32 v164, v164, v0
    v_mul_f32 v165, v165, v1
    v_mul_f32 v166, v166, v2
    v_mul_f32 v167, v167, v3
    v_mul_f32 v168, v168, v8
    v_mul_f32 v169, v169, v9
    v_mul_f32 v170, v170, v10
    v_mul_f32 v171, v171, v11
    v_mul_f32 v180, v180, v16
    s_waitcnt vmcnt(0) lgkmcnt(0)
    v_mfma_f32_16x16x32_bf16 v[28:31], v[124:127], v[152:155], v[28:31]
    v_mfma_f32_16x16x32_bf16 v[36:39], v[124:127], v[156:159], v[36:39]
    v_mfma_f32_16x16x32_bf16 v[44:47], v[124:127], v[160:163], v[44:47]
    v_mul_f32 v181, v181, v17
    v_mul_f32 v182, v182, v18
    v_mul_f32 v183, v183, v19
    v_lshlrev_b32 v0, 16, v48
    v_and_b32 v1, s81, v48
    v_lshlrev_b32 v2, 16, v49
    v_and_b32 v3, s81, v49
    v_lshlrev_b32 v8, 16, v52
    v_and_b32 v9, s81, v52
    v_lshlrev_b32 v10, 16, v53
    v_and_b32 v11, s81, v53
    v_lshlrev_b32 v16, 16, v56
    v_and_b32 v17, s81, v56
    v_lshlrev_b32 v18, 16, v57
    v_and_b32 v19, s81, v57
    v_fma_f32 v164, v164, s92, v0
    v_fma_f32 v165, v165, s92, v1
    v_fma_f32 v166, v166, s92, v2
    v_fma_f32 v167, v167, s92, v3
    v_fma_f32 v168, v168, s92, v8
    v_fma_f32 v169, v169, s92, v9
    v_fma_f32 v170, v170, s92, v10
    v_fma_f32 v171, v171, s92, v11
    v_fma_f32 v180, v180, s92, v16
    v_fma_f32 v181, v181, s92, v17
    v_fma_f32 v182, v182, s92, v18
    v_fma_f32 v183, v183, s92, v19
    v_cvt_pk_bf16_f32 v48, v164, v165
    v_cvt_pk_bf16_f32 v49, v166, v167
    v_cvt_pk_bf16_f32 v52, v168, v169
    v_cvt_pk_bf16_f32 v53, v170, v171
    v_cvt_pk_bf16_f32 v56, v180, v181
    v_cvt_pk_bf16_f32 v57, v182, v183
    s_cmp_ge_u32 s60, 2
    s_cbranch_scc1 K2_NOPST
    buffer_store_short v62, v60, s[48:51], s88 offen sc0 sc1
K2_NOPST:
    v_pk_fma_f32 v[4:5], v[28:29], s[84:85], v[4:5]
    v_pk_fma_f32 v[6:7], v[30:31], s[84:85], v[6:7]
    v_exp_f32 v164, -v4
    v_exp_f32 v165, -v5
    v_exp_f32 v166, -v6
    v_exp_f32 v167, -v7
    v_pk_add_f32 v[164:165], v[164:165], 1.0 op_sel_hi:[1,0]
    v_pk_add_f32 v[166:167], v[166:167], 1.0 op_sel_hi:[1,0]
    v_rcp_f32 v164, v164
    v_rcp_f32 v165, v165
    v_rcp_f32 v166, v166
    v_rcp_f32 v167, v167
    v_pk_mul_f32 v[164:165], v[164:165], v[4:5]
    v_pk_mul_f32 v[166:167], v[166:167], v[6:7]
    v_lshlrev_b32 v4, 16, v50
    v_and_b32 v5, s81, v50
    v_lshlrev_b32 v6, 16, v51
    v_and_b32 v7, s81, v51
    v_pk_fma_f32 v[164:165], v[164:165], s[92:93], v[4:5]
    v_pk_fma_f32 v[166:167], v[166:167], s[92:93], v[6:7]
    v_cvt_pk_bf16_f32 v50, v164, v165
    v_cvt_pk_bf16_f32 v51, v166, v167
    ds_write_b128 v177, v[48:51] offset:0
    ds_read_b128 v[128:131], v178 offset:0
    v_pk_fma_f32 v[12:13], v[36:37], s[84:85], v[12:13]
    v_pk_fma_f32 v[14:15], v[38:39], s[84:85], v[14:15]
    v_exp_f32 v168, -v12
    v_exp_f32 v169, -v13
    v_exp_f32 v170, -v14
    v_exp_f32 v171, -v15
    v_pk_add_f32 v[168:169], v[168:169], 1.0 op_sel_hi:[1,0]
    v_pk_add_f32 v[170:171], v[170:171], 1.0 op_sel_hi:[1,0]
    v_rcp_f32 v168, v168
    v_rcp_f32 v169, v169
    v_rcp_f32 v170, v170
    v_rcp_f32 v171, v171
    v_pk_mul_f32 v[168:169], v[168:169], v[12:13]
    v_pk_mul_f32 v[170:171], v[170:171], v[14:15]
    v_lshlrev_b32 v12, 16, v54
    v_and_b32 v13, s81, v54
    v_lshlrev_b32 v14, 16, v55
    v_and_b32 v15, s81, v55
    v_pk_fma_f32 v[168:169], v[168:169], s[92:93], v[12:13]
    v_pk_fma_f32 v[170:171], v[170:171], s[92:93], v[14:15]
    v_cvt_pk_bf16_f32 v54, v168, v169
    v_cvt_pk_bf16_f32 v55, v170, v171
    s_waitcnt lgkmcnt(0)
    buffer_store_dwordx4 v[128:131], v176, s[48:51], s23 offen sc0 sc1
    s_add_u32 s23, s23, 8192
    ds_write_b128 v177, v[52:55] offset:1024
    ds_read_b128 v[132:135], v178 offset:1024
    v_pk_fma_f32 v[20:21], v[44:45], s[84:85], v[20:21]
    v_pk_fma_f32 v[22:23], v[46:47], s[84:85], v[22:23]
    v_exp_f32 v180, -v20
    v_exp_f32 v181, -v21
    v_exp_f32 v182, -v22
    v_exp_f32 v183, -v23
    v_pk_add_f32 v[180:181], v[180:181], 1.0 op_sel_hi:[1,0]
    v_pk_add_f32 v[182:183], v[182:183], 1.0 op_sel_hi:[1,0]
    v_rcp_f32 v180, v180
    v_rcp_f32 v181, v181
    v_rcp_f32 v182, v182
    v_rcp_f32 v183, v183
    v_pk_mul_f32 v[180:181], v[180:181], v[20:21]
    v_pk_mul_f32 v[182:183], v[182:183], v[22:23]
    v_lshlrev_b32 v20, 16, v58
    v_and_b32 v21, s81, v58
    v_lshlrev_b32 v22, 16, v59
    v_and_b32 v23, s81, v59
    v_pk_fma_f32 v[180:181], v[180:181], s[92:93], v[20:21]
    v_pk_fma_f32 v[182:183], v[182:183], s[92:93], v[22:23]
    v_cvt_pk_bf16_f32 v58, v180, v181
    v_cvt_pk_bf16_f32 v59, v182, v183
    s_waitcnt lgkmcnt(0)
    buffer_store_dwordx4 v[132:135], v176, s[48:51], s23 offen sc0 sc1
    s_add_u32 s23, s23, 8192
    ds_write_b128 v177, v[56:59] offset:2048
    ds_read_b128 v[136:139], v178 offset:2048
    s_waitcnt lgkmcnt(0)
    s_mov_b32 exec_hi, 0
    buffer_store_dwordx4 v[136:139], v176, s[48:51], s23 offen sc0 sc1
    s_mov_b64 exec, -1
K2_END:
    s_endpgm
K2_MORE:
    v_add_u32 v195, 32, v195
    v_subrev_u32 v194, 4, v194
    buffer_load_dwordx4 v[204:207], v195, s[28:31], 0 offen offset:32
    s_waitcnt vmcnt(0)
    v_bfe_u32 v216, v205, 19, 3
    v_cmp_lt_i32 vcc, 4, v194
    v_mul_u32_u24 v216, 10, v216
    v_lshrrev_b32 v217, 22, v205
    v_lshrrev_b64 v[218:219], v216, v[202:203]
    v_and_b32 v218, 1023, v218
    v_add_lshl_u32 v218, v218, v217, 2
    v_add_u32 v218, 73216, v218
    s_mov_b64 exec, vcc
    ds_write_b32 v218, v204
    ds_write_b32 v218, v205 offset:3584
    s_mov_b64 exec, -1
    v_bfe_u32 v216, v207, 19, 3
    v_cmp_lt_i32 vcc, 5, v194
    v_mul_u32_u24 v216, 10, v216
    v_lshrrev_b32 v217, 22, v207
    v_lshrrev_b64 v[218:219], v216, v[202:203]
    v_and_b32 v218, 1023, v218
    v_add_lshl_u32 v218, v218, v217, 2
    v_add_u32 v218, 73216, v218
    s_mov_b64 exec, vcc
    ds_write_b32 v218, v206
    ds_write_b32 v218, v207 offset:3584
    s_mov_b64 exec, -1
    v_cmp_lt_i32 vcc, 8, v194
    s_nop 4
    s_cbranch_vccnz K2_MORE
    s_branch K2_NOMORE
K2_H2:
    s_bitcmp1_b32 s74, 0
    s_cbranch_scc0 K2_HP2b
    s_cmp_lg_u32 s64, 0
    s_cbranch_scc1 K2_FA3
K2_FB3:
    ds_read_b128 v[32:35], v181 offset:0
    ds_read_b128 v[36:39], v181 offset:32
    ds_read_b128 v[40:43], v181 offset:64
    ds_read_b128 v[44:47], v181 offset:96
    s_mul_i32 s80, s78, 1056
    s_lshl_b32 s81, s78, 7
    s_add_u32 s81, s81, s20
    v_cvt_pk_bf16_f32 v16, v64, v65
    v_cvt_pk_bf16_f32 v17, v66, v67
    v_cvt_pk_bf16_f32 v18, v68, v69
    v_cvt_pk_bf16_f32 v19, v70, v71
    v_cvt_pk_bf16_f32 v20, v72, v73
    v_cvt_pk_bf16_f32 v21, v74, v75
    v_cvt_pk_bf16_f32 v22, v76, v77
    v_cvt_pk_bf16_f32 v23, v78, v79
    v_mfma_f32_32x32x8_bf16 v[64:79], v[168:169], v[168:169], 0
    v_add_u32 v182, s80, v180
    v_lshl_add_u32 v183, v184, 2, s81
    v_cvt_pk_bf16_f32 v24, v80, v81
    v_cvt_pk_bf16_f32 v25, v82, v83
    v_cvt_pk_bf16_f32 v26, v84, v85
    v_cvt_pk_bf16_f32 v27, v86, v87
    v_cvt_pk_bf16_f32 v28, v88, v89
    v_cvt_pk_bf16_f32 v29, v90, v91
    v_cvt_pk_bf16_f32 v30, v92, v93
    v_cvt_pk_bf16_f32 v31, v94, v95
    s_waitcnt lgkmcnt(0)
    s_mov_b64 exec, s[90:91]
    v_mfma_f32_32x32x16_bf16 v[80:95], v[32:35], v[16:19], 0
    ds_write_b64 v182, v[16:17] offset:0
    ds_write_b64 v182, v[18:19] offset:16
    ds_write_b64 v182, v[20:21] offset:32
    v_mfma_f32_32x32x16_bf16 v[80:95], v[36:39], v[20:23], v[80:95]
    ds_write_b64 v182, v[22:23] offset:48
    ds_write_b64 v182, v[24:25] offset:64
    ds_write_b64 v182, v[26:27] offset:80
    v_mfma_f32_32x32x16_bf16 v[80:95], v[40:43], v[24:27], v[80:95]
    ds_write_b64 v182, v[28:29] offset:96
    ds_write_b64 v182, v[30:31] offset:112
    s_mov_b64 exec, -1
    v_mfma_f32_32x32x16_bf16 v[80:95], v[44:47], v[28:31], v[80:95]
    s_and_b32 s78, s3, 255
    s_lshr_b32 s3, s3, 8
    s_nop 5
    s_bitcmp1_b32 s74, 2
    s_cbranch_scc0 K2_HD2a
K2_HP2a:
    s_set_gpr_idx_on s73, gpr_idx(SRC0)
    v_mov_b32 v148, v128
    v_mov_b32 v149, v129
    v_mov_b32 v150, v130
    v_mov_b32 v151, v131
    s_set_gpr_idx_off
    s_lshr_b32 s73, s73, 8
    s_mov_b32 m0, s79
K2_HD2a:
    s_cmp_ge_u32 s59, 4
    s_cbranch_scc1 K2_HT2
    s_add_u32 s59, s59, 1
    s_cmp_lg_u32 s59, 1
    s_cbranch_scc1 K2_W2a_1
    buffer_load_dwordx4 v[192:195], v191, s[36:39], s86 offen offset:0
    buffer_load_dwordx4 v[196:199], v191, s[36:39], s86 offen offset:1024
    buffer_load_dwordx4 v[200:203], v191, s[36:39], s86 offen offset:2048
    buffer_load_dwordx4 v[204:207], v191, s[36:39], s86 offen offset:3072
    s_add_u32 s86, s86, 4096
    s_branch K2_HT2
K2_W2a_1:
    s_cmp_lg_u32 s59, 2
    s_cbranch_scc1 K2_W2a_2
    buffer_load_dwordx4 v[208:211], v191, s[36:39], s86 offen offset:0
    buffer_load_dwordx4 v[212:215], v191, s[36:39], s86 offen offset:1024
    buffer_load_dwordx4 v[216:219], v191, s[36:39], s86 offen offset:2048
    buffer_load_dwordx4 v[220:223], v191, s[36:39], s86 offen offset:3072
    s_add_u32 s86, s86, 4096
    s_branch K2_HT2
K2_W2a_2:
    s_cmp_lg_u32 s59, 3
    s_cbranch_scc1 K2_W2a_3
    buffer_load_dwordx4 v[224:227], v191, s[36:39], s86 offen offset:0
    buffer_load_dwordx4 v[228:231], v191, s[36:39], s86 offen offset:1024
    buffer_load_dwordx4 v[232:235], v191, s[36:39], s86 offen offset:2048
    buffer_load_dwordx4 v[236:239], v191, s[36:39], s86 offen offset:3072
    s_add_u32 s86, s86, 4096
    s_branch K2_HT2
K2_W2a_3:
    buffer_load_dwordx4 v[240:243], v191, s[36:39], s86 offen offset:0
    buffer_load_dwordx4 v[244:247], v191, s[36:39], s86 offen offset:1024
    buffer_load_dwordx4 v[248:251], v191, s[36:39], s86 offen offset:2048
    buffer_load_dwordx4 v[252:255], v191, s[36:39], s86 offen offset:3072
    s_add_u32 s86, s86, 4294955008
    s_branch K2_HT2
K2_HT2:
    v_add_f32 v182, v190, v80
    s_mov_b32 exec_hi, 0
    ds_write_b32 v183, v182
    s_mov_b32 exec_hi, -1
    v_mfma_f32_32x32x8_bf16 v[80:95], v[168:169], v[168:169], 0
    s_branch K2_R2
    s_bitcmp1_b32 s74, 2
    s_cbranch_scc0 K2_HD2b
K2_HP2b:
    s_set_gpr_idx_on s73, gpr_idx(SRC0)
    v_mov_b32 v148, v128
    v_mov_b32 v149, v129
    v_mov_b32 v150, v130
    v_mov_b32 v151, v131
    s_set_gpr_idx_off
    s_lshr_b32 s73, s73, 8
    s_mov_b32 m0, s79
K2_HD2b:
    s_cmp_ge_u32 s59, 4
    s_cbranch_scc1 K2_R2
    s_add_u32 s59, s59, 1
    s_cmp_lg_u32 s59, 1
    s_cbranch_scc1 K2_W2b_1
    buffer_load_dwordx4 v[192:195], v191, s[36:39], s86 offen offset:0
    buffer_load_dwordx4 v[196:199], v191, s[36:39], s86 offen offset:1024
    buffer_load_dwordx4 v[200:203], v191, s[36:39], s86 offen offset:2048
    buffer_load_dwordx4 v[204:207], v191, s[36:39], s86 offen offset:3072
    s_add_u32 s86, s86, 4096
    s_branch K2_R2
K2_W2b_1:
    s_cmp_lg_u32 s59, 2
    s_cbranch_scc1 K2_W2b_2
    buffer_load_dwordx4 v[208:211], v191, s[36:39], s86 offen offset:0
    buffer_load_dwordx4 v[212:215], v191, s[36:39], s86 offen offset:1024
    buffer_load_dwordx4 v[216:219], v191, s[36:39], s86 offen offset:2048
    buffer_load_dwordx4 v[220:223], v191, s[36:39], s86 offen offset:3072
    s_add_u32 s86, s86, 4096
    s_branch K2_R2
K2_W2b_2:
    s_cmp_lg_u32 s59, 3
    s_cbranch_scc1 K2_W2b_3
    buffer_load_dwordx4 v[224:227], v191, s[36:39], s86 offen offset:0
    buffer_load_dwordx4 v[228:231], v191, s[36:39], s86 offen offset:1024
    buffer_load_dwordx4 v[232:235], v191, s[36:39], s86 offen offset:2048
    buffer_load_dwordx4 v[236:239], v191, s[36:39], s86 offen offset:3072
    s_add_u32 s86, s86, 4096
    s_branch K2_R2
K2_W2b_3:
    buffer_load_dwordx4 v[240:243], v191, s[36:39], s86 offen offset:0
    buffer_load_dwordx4 v[244:247], v191, s[36:39], s86 offen offset:1024
    buffer_load_dwordx4 v[248:251], v191, s[36:39], s86 offen offset:2048
    buffer_load_dwordx4 v[252:255], v191, s[36:39], s86 offen offset:3072
    s_add_u32 s86, s86, 4294955008
    s_branch K2_R2
K2_FA3:
    s_lshl_b32 s81, s78, 7
    s_add_u32 s81, s81, s20
    v_lshl_add_u32 v183, v184, 2, s81
    ds_read_b32 v190, v183
    s_lshl_b32 s80, s78, 11
    s_lshl_b32 s81, s61, 8
    s_add_u32 s80, s80, s81
    v_and_b32 v182, 7, v184
    v_lshrrev_b32 v183, 5, v184
    v_lshlrev_b32 v183, 4, v183
    v_lshl_or_b32 v182, v182, 10, v183
    s_mov_b64 exec, s[90:91]
    buffer_load_dwordx4 v[16:19], v182, s[52:55], s80 offen offset:0 sc1
    buffer_load_dwordx4 v[20:23], v182, s[52:55], s80 offen offset:32 sc1
    buffer_load_dwordx4 v[24:27], v182, s[52:55], s80 offen offset:64 sc1
    buffer_load_dwordx4 v[28:31], v182, s[52:55], s80 offen offset:96 sc1
    s_waitcnt vmcnt(0)
    v_pk_add_f32 v[16:17], v[16:17], v[64:65]
    v_pk_add_f32 v[18:19], v[18:19], v[66:67]
    v_pk_add_f32 v[20:21], v[20:21], v[68:69]
    v_pk_add_f32 v[22:23], v[22:23], v[70:71]
    v_pk_add_f32 v[24:25], v[24:25], v[72:73]
    v_pk_add_f32 v[26:27], v[26:27], v[74:75]
    v_pk_add_f32 v[28:29], v[28:29], v[76:77]
    v_pk_add_f32 v[30:31], v[30:31], v[78:79]
    buffer_store_dwordx4 v[16:19], v182, s[52:55], s80 offen offset:0
    buffer_store_dwordx4 v[20:23], v182, s[52:55], s80 offen offset:32
    buffer_store_dwordx4 v[24:27], v182, s[52:55], s80 offen offset:64
    buffer_store_dwordx4 v[28:31], v182, s[52:55], s80 offen offset:96
    s_waitcnt vmcnt(0) lgkmcnt(0)
    buffer_load_dwordx4 v[16:19], v182, s[52:55], s80 offen offset:128 sc1
    buffer_load_dwordx4 v[20:23], v182, s[52:55], s80 offen offset:160 sc1
    buffer_load_dwordx4 v[24:27], v182, s[52:55], s80 offen offset:192 sc1
    buffer_load_dwordx4 v[28:31], v182, s[52:55], s80 offen offset:224 sc1
    s_waitcnt vmcnt(0)
    v_pk_add_f32 v[16:17], v[16:17], v[80:81]
    v_pk_add_f32 v[18:19], v[18:19], v[82:83]
    v_pk_add_f32 v[20:21], v[20:21], v[84:85]
    v_pk_add_f32 v[22:23], v[22:23], v[86:87]
    v_pk_add_f32 v[24:25], v[24:25], v[88:89]
    v_pk_add_f32 v[26:27], v[26:27], v[90:91]
    v_pk_add_f32 v[28:29], v[28:29], v[92:93]
    v_pk_add_f32 v[30:31], v[30:31], v[94:95]
    buffer_store_dwordx4 v[16:19], v182, s[52:55], s80 offen offset:128
    buffer_store_dwordx4 v[20:23], v182, s[52:55], s80 offen offset:160
    buffer_store_dwordx4 v[24:27], v182, s[52:55], s80 offen offset:192
    buffer_store_dwordx4 v[28:31], v182, s[52:55], s80 offen offset:224
    s_waitcnt vmcnt(0) lgkmcnt(0)
    s_mov_b64 exec, -1
    s_branch K2_FB3
K2_H4:
    s_bitcmp1_b32 s74, 1
    s_cbranch_scc0 K2_HP4b
    s_cmp_eq_u32 s78, -1
    s_cbranch_scc1 K2_H04
    s_cmp_lg_u32 s64, 0
    s_cbranch_scc1 K2_FA5
K2_FB5:
    ds_read_b128 v[96:99], v181 offset:0
    ds_read_b128 v[100:103], v181 offset:32
    s_mul_i32 s80, s78, 1056
    s_lshl_b32 s81, s78, 7
    s_add_u32 s81, s81, s20
    v_cvt_pk_bf16_f32 v0, v64, v65
    v_cvt_pk_bf16_f32 v1, v66, v67
    v_cvt_pk_bf16_f32 v2, v68, v69
    v_cvt_pk_bf16_f32 v3, v70, v71
    v_cvt_pk_bf16_f32 v4, v72, v73
    v_cvt_pk_bf16_f32 v5, v74, v75
    v_cvt_pk_bf16_f32 v6, v76, v77
    v_cvt_pk_bf16_f32 v7, v78, v79
    ds_read_b128 v[64:67], v181 offset:64
    ds_read_b128 v[68:71], v181 offset:96
    v_add_u32 v182, s80, v180
    v_lshl_add_u32 v183, v184, 2, s81
    v_cvt_pk_bf16_f32 v8, v80, v81
    v_cvt_pk_bf16_f32 v9, v82, v83
    v_cvt_pk_bf16_f32 v10, v84, v85
    v_cvt_pk_bf16_f32 v11, v86, v87
    v_cvt_pk_bf16_f32 v12, v88, v89
    v_cvt_pk_bf16_f32 v13, v90, v91
    v_cvt_pk_bf16_f32 v14, v92, v93
    v_cvt_pk_bf16_f32 v15, v94, v95
    s_waitcnt lgkmcnt(2)
    s_mov_b64 exec, s[90:91]
    v_mfma_f32_32x32x16_bf16 v[80:95], v[96:99], v[0:3], 0
    ds_write_b64 v182, v[0:1] offset:0
    ds_write_b64 v182, v[2:3] offset:16
    ds_write_b64 v182, v[4:5] offset:32
    v_mfma_f32_32x32x16_bf16 v[80:95], v[100:103], v[4:7], v[80:95]
    ds_write_b64 v182, v[6:7] offset:48
    ds_write_b64 v182, v[8:9] offset:64
    ds_write_b64 v182, v[10:11] offset:80
    s_waitcnt lgkmcnt(6)
    v_mfma_f32_32x32x16_bf16 v[80:95], v[64:67], v[8:11], v[80:95]
    ds_write_b64 v182, v[12:13] offset:96
    ds_write_b64 v182, v[14:15] offset:112
    s_mov_b64 exec, -1
    v_mfma_f32_32x32x16_bf16 v[80:95], v[68:71], v[12:15], v[80:95]
    v_mfma_f32_32x32x8_bf16 v[64:79], v[168:169], v[168:169], 0
    s_and_b32 s78, s3, 255
    s_lshr_b32 s3, s3, 8
    s_nop 5
    s_bitcmp1_b32 s74, 3
    s_cbranch_scc0 K2_HD4a
K2_HP4a:
    s_set_gpr_idx_on s73, gpr_idx(SRC0)
    v_mov_b32 v148, v128
    v_mov_b32 v149, v129
    v_mov_b32 v150, v130
    v_mov_b32 v151, v131
    s_set_gpr_idx_off
    s_lshr_b32 s73, s73, 8
    s_mov_b32 m0, s79
K2_HD4a:
    s_cmp_ge_u32 s59, 4
    s_cbranch_scc1 K2_HT4
    s_add_u32 s59, s59, 1
    s_cmp_lg_u32 s59, 1
    s_cbranch_scc1 K2_W4a_1
    buffer_load_dwordx4 v[192:195], v191, s[36:39], s86 offen offset:0
    buffer_load_dwordx4 v[196:199], v191, s[36:39], s86 offen offset:1024
    buffer_load_dwordx4 v[200:203], v191, s[36:39], s86 offen offset:2048
    buffer_load_dwordx4 v[204:207], v191, s[36:39], s86 offen offset:3072
    s_add_u32 s86, s86, 4096
    s_branch K2_HT4
K2_W4a_1:
    s_cmp_lg_u32 s59, 2
    s_cbranch_scc1 K2_W4a_2
    buffer_load_dwordx4 v[208:211], v191, s[36:39], s86 offen offset:0
    buffer_load_dwordx4 v[212:215], v191, s[36:39], s86 offen offset:1024
    buffer_load_dwordx4 v[216:219], v191, s[36:39], s86 offen offset:2048
    buffer_load_dwordx4 v[220:223], v191, s[36:39], s86 offen offset:3072
    s_add_u32 s86, s86, 4096
    s_branch K2_HT4
K2_W4a_2:
    s_cmp_lg_u32 s59, 3
    s_cbranch_scc1 K2_W4a_3
    buffer_load_dwordx4 v[224:227], v191, s[36:39], s86 offen offset:0
    buffer_load_dwordx4 v[228:231], v191, s[36:39], s86 offen offset:1024
    buffer_load_dwordx4 v[232:235], v191, s[36:39], s86 offen offset:2048
    buffer_load_dwordx4 v[236:239], v191, s[36:39], s86 offen offset:3072
    s_add_u32 s86, s86, 4096
    s_branch K2_HT4
K2_W4a_3:
    buffer_load_dwordx4 v[240:243], v191, s[36:39], s86 offen offset:0
    buffer_load_dwordx4 v[244:247], v191, s[36:39], s86 offen offset:1024
    buffer_load_dwordx4 v[248:251], v191, s[36:39], s86 offen offset:2048
    buffer_load_dwordx4 v[252:255], v191, s[36:39], s86 offen offset:3072
    s_add_u32 s86, s86, 4294955008
    s_branch K2_HT4
K2_HT4:
    v_add_f32 v182, v190, v80
    s_mov_b32 exec_hi, 0
    ds_write_b32 v183, v182
    s_mov_b32 exec_hi, -1
    v_mfma_f32_32x32x8_bf16 v[80:95], v[168:169], v[168:169], 0
    s_branch K2_R4
K2_H04:
    v_mfma_f32_32x32x8_bf16 v[64:79], v[168:169], v[168:169], 0
    v_mfma_f32_32x32x8_bf16 v[80:95], v[168:169], v[168:169], 0
    s_lshl_b32 s87, s89, 1
    s_mov_b32 s23, 0
    s_cmp_lg_u32 s67, s68
    s_cselect_b32 s80, 1, 0
    s_cmp_lg_u32 s67, s87
    s_cselect_b32 s80, s80, 0
    s_or_b32 s23, s23, s80
    s_cmp_lg_u32 s68, s69
    s_cselect_b32 s80, 2, 0
    s_cmp_lg_u32 s68, s87
    s_cselect_b32 s80, s80, 0
    s_or_b32 s23, s23, s80
    s_cmp_lg_u32 s69, s70
    s_cselect_b32 s80, 4, 0
    s_cmp_lg_u32 s69, s87
    s_cselect_b32 s80, s80, 0
    s_or_b32 s23, s23, s80
    s_cmp_lg_u32 s70, s71
    s_cselect_b32 s80, 8, 0
    s_cmp_lg_u32 s70, s87
    s_cselect_b32 s80, s80, 0
    s_or_b32 s23, s23, s80
    s_cmp_lg_u32 s71, s72
    s_cselect_b32 s80, 16, 0
    s_cmp_lg_u32 s71, s87
    s_cselect_b32 s80, s80, 0
    s_or_b32 s23, s23, s80
    s_cmp_lt_u32 s87, s72
    s_cselect_b32 s80, 32, 0
    s_or_b32 s23, s23, s80
    s_cmp_lg_u32 s64, 0
    s_cselect_b32 s23, 31, s23
    s_mov_b32 s21, 0
    s_cmp_ge_u32 s87, s68
    s_addc_u32 s21, s21, 0
    s_cmp_ge_u32 s87, s69
    s_addc_u32 s21, s21, 0
    s_cmp_ge_u32 s87, s70
    s_addc_u32 s21, s21, 0
    s_cmp_ge_u32 s87, s71
    s_addc_u32 s21, s21, 0
    s_cmp_eq_u32 s62, 0
    s_cselect_b32 s78, s22, 20
    s_bitcmp1_b32 s74, 3
    s_cbranch_scc0 K2_HD4b
K2_HP4b:
    s_set_gpr_idx_on s73, gpr_idx(SRC0)
    v_mov_b32 v148, v128
    v_mov_b32 v149, v129
    v_mov_b32 v150, v130
    v_mov_b32 v151, v131
    s_set_gpr_idx_off
    s_lshr_b32 s73, s73, 8
    s_mov_b32 m0, s79
K2_HD4b:
    s_cmp_ge_u32 s59, 4
    s_cbranch_scc1 K2_R4
    s_add_u32 s59, s59, 1
    s_cmp_lg_u32 s59, 1
    s_cbranch_scc1 K2_W4b_1
    buffer_load_dwordx4 v[192:195], v191, s[36:39], s86 offen offset:0
    buffer_load_dwordx4 v[196:199], v191, s[36:39], s86 offen offset:1024
    buffer_load_dwordx4 v[200:203], v191, s[36:39], s86 offen offset:2048
    buffer_load_dwordx4 v[204:207], v191, s[36:39], s86 offen offset:3072
    s_add_u32 s86, s86, 4096
    s_branch K2_R4
K2_W4b_1:
    s_cmp_lg_u32 s59, 2
    s_cbranch_scc1 K2_W4b_2
    buffer_load_dwordx4 v[208:211], v191, s[36:39], s86 offen offset:0
    buffer_load_dwordx4 v[212:215], v191, s[36:39], s86 offen offset:1024
    buffer_load_dwordx4 v[216:219], v191, s[36:39], s86 offen offset:2048
    buffer_load_dwordx4 v[220:223], v191, s[36:39], s86 offen offset:3072
    s_add_u32 s86, s86, 4096
    s_branch K2_R4
K2_W4b_2:
    s_cmp_lg_u32 s59, 3
    s_cbranch_scc1 K2_W4b_3
    buffer_load_dwordx4 v[224:227], v191, s[36:39], s86 offen offset:0
    buffer_load_dwordx4 v[228:231], v191, s[36:39], s86 offen offset:1024
    buffer_load_dwordx4 v[232:235], v191, s[36:39], s86 offen offset:2048
    buffer_load_dwordx4 v[236:239], v191, s[36:39], s86 offen offset:3072
    s_add_u32 s86, s86, 4096
    s_branch K2_R4
K2_W4b_3:
    buffer_load_dwordx4 v[240:243], v191, s[36:39], s86 offen offset:0
    buffer_load_dwordx4 v[244:247], v191, s[36:39], s86 offen offset:1024
    buffer_load_dwordx4 v[248:251], v191, s[36:39], s86 offen offset:2048
    buffer_load_dwordx4 v[252:255], v191, s[36:39], s86 offen offset:3072
    s_add_u32 s86, s86, 4294955008
    s_branch K2_R4
K2_FA5:
    s_lshl_b32 s81, s78, 7
    s_add_u32 s81, s81, s20
    v_lshl_add_u32 v183, v184, 2, s81
    ds_read_b32 v190, v183
    s_lshl_b32 s80, s78, 11
    s_lshl_b32 s81, s61, 8
    s_add_u32 s80, s80, s81
    v_and_b32 v182, 7, v184
    v_lshrrev_b32 v183, 5, v184
    v_lshlrev_b32 v183, 4, v183
    v_lshl_or_b32 v182, v182, 10, v183
    s_mov_b64 exec, s[90:91]
    buffer_load_dwordx4 v[0:3], v182, s[52:55], s80 offen offset:0 sc1
    buffer_load_dwordx4 v[4:7], v182, s[52:55], s80 offen offset:32 sc1
    buffer_load_dwordx4 v[8:11], v182, s[52:55], s80 offen offset:64 sc1
    buffer_load_dwordx4 v[12:15], v182, s[52:55], s80 offen offset:96 sc1
    s_waitcnt vmcnt(0)
    v_pk_add_f32 v[0:1], v[0:1], v[64:65]
    v_pk_add_f32 v[2:3], v[2:3], v[66:67]
    v_pk_add_f32 v[4:5], v[4:5], v[68:69]
    v_pk_add_f32 v[6:7], v[6:7], v[70:71]
    v_pk_add_f32 v[8:9], v[8:9], v[72:73]
    v_pk_add_f32 v[10:11], v[10:11], v[74:75]
    v_pk_add_f32 v[12:13], v[12:13], v[76:77]
    v_pk_add_f32 v[14:15], v[14:15], v[78:79]
    buffer_store_dwordx4 v[0:3], v182, s[52:55], s80 offen offset:0
    buffer_store_dwordx4 v[4:7], v182, s[52:55], s80 offen offset:32
    buffer_store_dwordx4 v[8:11], v182, s[52:55], s80 offen offset:64
    buffer_store_dwordx4 v[12:15], v182, s[52:55], s80 offen offset:96
    s_waitcnt vmcnt(0) lgkmcnt(0)
    buffer_load_dwordx4 v[0:3], v182, s[52:55], s80 offen offset:128 sc1
    buffer_load_dwordx4 v[4:7], v182, s[52:55], s80 offen offset:160 sc1
    buffer_load_dwordx4 v[8:11], v182, s[52:55], s80 offen offset:192 sc1
    buffer_load_dwordx4 v[12:15], v182, s[52:55], s80 offen offset:224 sc1
    s_waitcnt vmcnt(0)
    v_pk_add_f32 v[0:1], v[0:1], v[80:81]
    v_pk_add_f32 v[2:3], v[2:3], v[82:83]
    v_pk_add_f32 v[4:5], v[4:5], v[84:85]
    v_pk_add_f32 v[6:7], v[6:7], v[86:87]
    v_pk_add_f32 v[8:9], v[8:9], v[88:89]
    v_pk_add_f32 v[10:11], v[10:11], v[90:91]
    v_pk_add_f32 v[12:13], v[12:13], v[92:93]
    v_pk_add_f32 v[14:15], v[14:15], v[94:95]
    buffer_store_dwordx4 v[0:3], v182, s[52:55], s80 offen offset:128
    buffer_store_dwordx4 v[4:7], v182, s[52:55], s80 offen offset:160
    buffer_store_dwordx4 v[8:11], v182, s[52:55], s80 offen offset:192
    buffer_store_dwordx4 v[12:15], v182, s[52:55], s80 offen offset:224
    s_waitcnt vmcnt(0) lgkmcnt(0)
    s_mov_b64 exec, -1
    s_branch K2_FB5
K2_H6:
    s_cmp_lg_u32 s64, 0
    s_cbranch_scc1 K2_FA7
K2_FB7:
    ds_read_b128 v[32:35], v181 offset:0
    ds_read_b128 v[36:39], v181 offset:32
    ds_read_b128 v[40:43], v181 offset:64
    ds_read_b128 v[44:47], v181 offset:96
    s_mul_i32 s80, s78, 1056
    s_lshl_b32 s81, s78, 7
    s_add_u32 s81, s81, s20
    v_cvt_pk_bf16_f32 v16, v64, v65
    v_cvt_pk_bf16_f32 v17, v66, v67
    v_cvt_pk_bf16_f32 v18, v68, v69
    v_cvt_pk_bf16_f32 v19, v70, v71
    v_cvt_pk_bf16_f32 v20, v72, v73
    v_cvt_pk_bf16_f32 v21, v74, v75
    v_cvt_pk_bf16_f32 v22, v76, v77
    v_cvt_pk_bf16_f32 v23, v78, v79
    v_mfma_f32_32x32x8_bf16 v[64:79], v[168:169], v[168:169], 0
    v_add_u32 v182, s80, v180
    v_lshl_add_u32 v183, v184, 2, s81
    v_cvt_pk_bf16_f32 v24, v80, v81
    v_cvt_pk_bf16_f32 v25, v82, v83
    v_cvt_pk_bf16_f32 v26, v84, v85
    v_cvt_pk_bf16_f32 v27, v86, v87
    v_cvt_pk_bf16_f32 v28, v88, v89
    v_cvt_pk_bf16_f32 v29, v90, v91
    v_cvt_pk_bf16_f32 v30, v92, v93
    v_cvt_pk_bf16_f32 v31, v94, v95
    s_waitcnt lgkmcnt(0)
    s_mov_b64 exec, s[90:91]
    v_mfma_f32_32x32x16_bf16 v[80:95], v[32:35], v[16:19], 0
    ds_write_b64 v182, v[16:17] offset:0
    ds_write_b64 v182, v[18:19] offset:16
    ds_write_b64 v182, v[20:21] offset:32
    v_mfma_f32_32x32x16_bf16 v[80:95], v[36:39], v[20:23], v[80:95]
    ds_write_b64 v182, v[22:23] offset:48
    ds_write_b64 v182, v[24:25] offset:64
    ds_write_b64 v182, v[26:27] offset:80
    v_mfma_f32_32x32x16_bf16 v[80:95], v[40:43], v[24:27], v[80:95]
    ds_write_b64 v182, v[28:29] offset:96
    ds_write_b64 v182, v[30:31] offset:112
    s_mov_b64 exec, -1
    v_mfma_f32_32x32x16_bf16 v[80:95], v[44:47], v[28:31], v[80:95]
    s_and_b32 s78, s3, 255
    s_lshr_b32 s3, s3, 8
    s_nop 7
    s_cmp_ge_u32 s59, 4
    s_cbranch_scc1 K2_HT6
    s_add_u32 s59, s59, 1
    s_cmp_lg_u32 s59, 1
    s_cbranch_scc1 K2_W6a_1
    buffer_load_dwordx4 v[192:195], v191, s[36:39], s86 offen offset:0
    buffer_load_dwordx4 v[196:199], v191, s[36:39], s86 offen offset:1024
    buffer_load_dwordx4 v[200:203], v191, s[36:39], s86 offen offset:2048
    buffer_load_dwordx4 v[204:207], v191, s[36:39], s86 offen offset:3072
    s_add_u32 s86, s86, 4096
    s_branch K2_HT6
K2_W6a_1:
    s_cmp_lg_u32 s59, 2
    s_cbranch_scc1 K2_W6a_2
    buffer_load_dwordx4 v[208:211], v191, s[36:39], s86 offen offset:0
    buffer_load_dwordx4 v[212:215], v191, s[36:39], s86 offen offset:1024
    buffer_load_dwordx4 v[216:219], v191, s[36:39], s86 offen offset:2048
    buffer_load_dwordx4 v[220:223], v191, s[36:39], s86 offen offset:3072
    s_add_u32 s86, s86, 4096
    s_branch K2_HT6
K2_W6a_2:
    s_cmp_lg_u32 s59, 3
    s_cbranch_scc1 K2_W6a_3
    buffer_load_dwordx4 v[224:227], v191, s[36:39], s86 offen offset:0
    buffer_load_dwordx4 v[228:231], v191, s[36:39], s86 offen offset:1024
    buffer_load_dwordx4 v[232:235], v191, s[36:39], s86 offen offset:2048
    buffer_load_dwordx4 v[236:239], v191, s[36:39], s86 offen offset:3072
    s_add_u32 s86, s86, 4096
    s_branch K2_HT6
K2_W6a_3:
    buffer_load_dwordx4 v[240:243], v191, s[36:39], s86 offen offset:0
    buffer_load_dwordx4 v[244:247], v191, s[36:39], s86 offen offset:1024
    buffer_load_dwordx4 v[248:251], v191, s[36:39], s86 offen offset:2048
    buffer_load_dwordx4 v[252:255], v191, s[36:39], s86 offen offset:3072
    s_add_u32 s86, s86, 4294955008
    s_branch K2_HT6
K2_HT6:
    v_add_f32 v182, v190, v80
    s_mov_b32 exec_hi, 0
    ds_write_b32 v183, v182
    s_mov_b32 exec_hi, -1
    v_mfma_f32_32x32x8_bf16 v[80:95], v[168:169], v[168:169], 0
    s_branch K2_R6
K2_FA7:
    s_lshl_b32 s81, s78, 7
    s_add_u32 s81, s81, s20
    v_lshl_add_u32 v183, v184, 2, s81
    ds_read_b32 v190, v183
    s_lshl_b32 s80, s78, 11
    s_lshl_b32 s81, s61, 8
    s_add_u32 s80, s80, s81
    v_and_b32 v182, 7, v184
    v_lshrrev_b32 v183, 5, v184
    v_lshlrev_b32 v183, 4, v183
    v_lshl_or_b32 v182, v182, 10, v183
    s_mov_b64 exec, s[90:91]
    buffer_load_dwordx4 v[16:19], v182, s[52:55], s80 offen offset:0 sc1
    buffer_load_dwordx4 v[20:23], v182, s[52:55], s80 offen offset:32 sc1
    buffer_load_dwordx4 v[24:27], v182, s[52:55], s80 offen offset:64 sc1
    buffer_load_dwordx4 v[28:31], v182, s[52:55], s80 offen offset:96 sc1
    s_waitcnt vmcnt(0)
    v_pk_add_f32 v[16:17], v[16:17], v[64:65]
    v_pk_add_f32 v[18:19], v[18:19], v[66:67]
    v_pk_add_f32 v[20:21], v[20:21], v[68:69]
    v_pk_add_f32 v[22:23], v[22:23], v[70:71]
    v_pk_add_f32 v[24:25], v[24:25], v[72:73]
    v_pk_add_f32 v[26:27], v[26:27], v[74:75]
    v_pk_add_f32 v[28:29], v[28:29], v[76:77]
    v_pk_add_f32 v[30:31], v[30:31], v[78:79]
    buffer_store_dwordx4 v[16:19], v182, s[52:55], s80 offen offset:0
    buffer_store_dwordx4 v[20:23], v182, s[52:55], s80 offen offset:32
    buffer_store_dwordx4 v[24:27], v182, s[52:55], s80 offen offset:64
    buffer_store_dwordx4 v[28:31], v182, s[52:55], s80 offen offset:96
    s_waitcnt vmcnt(0) lgkmcnt(0)
    buffer_load_dwordx4 v[16:19], v182, s[52:55], s80 offen offset:128 sc1
    buffer_load_dwordx4 v[20:23], v182, s[52:55], s80 offen offset:160 sc1
    buffer_load_dwordx4 v[24:27], v182, s[52:55], s80 offen offset:192 sc1
    buffer_load_dwordx4 v[28:31], v182, s[52:55], s80 offen offset:224 sc1
    s_waitcnt vmcnt(0)
    v_pk_add_f32 v[16:17], v[16:17], v[80:81]
    v_pk_add_f32 v[18:19], v[18:19], v[82:83]
    v_pk_add_f32 v[20:21], v[20:21], v[84:85]
    v_pk_add_f32 v[22:23], v[22:23], v[86:87]
    v_pk_add_f32 v[24:25], v[24:25], v[88:89]
    v_pk_add_f32 v[26:27], v[26:27], v[90:91]
    v_pk_add_f32 v[28:29], v[28:29], v[92:93]
    v_pk_add_f32 v[30:31], v[30:31], v[94:95]
    buffer_store_dwordx4 v[16:19], v182, s[52:55], s80 offen offset:128
    buffer_store_dwordx4 v[20:23], v182, s[52:55], s80 offen offset:160
    buffer_store_dwordx4 v[24:27], v182, s[52:55], s80 offen offset:192
    buffer_store_dwordx4 v[28:31], v182, s[52:55], s80 offen offset:224
    s_waitcnt vmcnt(0) lgkmcnt(0)
    s_mov_b64 exec, -1
    s_branch K2_FB7
K2_FA8:
    s_lshl_b32 s81, s78, 7
    s_add_u32 s81, s81, s20
    v_lshl_add_u32 v183, v184, 2, s81
    ds_read_b32 v190, v183
    s_lshl_b32 s80, s78, 11
    s_lshl_b32 s81, s61, 8
    s_add_u32 s80, s80, s81
    v_and_b32 v182, 7, v184
    v_lshrrev_b32 v183, 5, v184
    v_lshlrev_b32 v183, 4, v183
    v_lshl_or_b32 v182, v182, 10, v183
    s_mov_b64 exec, s[90:91]
    buffer_load_dwordx4 v[16:19], v182, s[52:55], s80 offen offset:0 sc1
    buffer_load_dwordx4 v[20:23], v182, s[52:55], s80 offen offset:32 sc1
    buffer_load_dwordx4 v[24:27], v182, s[52:55], s80 offen offset:64 sc1
    buffer_load_dwordx4 v[28:31], v182, s[52:55], s80 offen offset:96 sc1
    s_waitcnt vmcnt(0)
    v_pk_add_f32 v[16:17], v[16:17], v[64:65]
    v_pk_add_f32 v[18:19], v[18:19], v[66:67]
    v_pk_add_f32 v[20:21], v[20:21], v[68:69]
    v_pk_add_f32 v[22:23], v[22:23], v[70:71]
    v_pk_add_f32 v[24:25], v[24:25], v[72:73]
    v_pk_add_f32 v[26:27], v[26:27], v[74:75]
    v_pk_add_f32 v[28:29], v[28:29], v[76:77]
    v_pk_add_f32 v[30:31], v[30:31], v[78:79]
    buffer_store_dwordx4 v[16:19], v182, s[52:55], s80 offen offset:0
    buffer_store_dwordx4 v[20:23], v182, s[52:55], s80 offen offset:32
    buffer_store_dwordx4 v[24:27], v182, s[52:55], s80 offen offset:64
    buffer_store_dwordx4 v[28:31], v182, s[52:55], s80 offen offset:96
    s_waitcnt vmcnt(0) lgkmcnt(0)
    buffer_load_dwordx4 v[16:19], v182, s[52:55], s80 offen offset:128 sc1
    buffer_load_dwordx4 v[20:23], v182, s[52:55], s80 offen offset:160 sc1
    buffer_load_dwordx4 v[24:27], v182, s[52:55], s80 offen offset:192 sc1
    buffer_load_dwordx4 v[28:31], v182, s[52:55], s80 offen offset:224 sc1
    s_waitcnt vmcnt(0)
    v_pk_add_f32 v[16:17], v[16:17], v[80:81]
    v_pk_add_f32 v[18:19], v[18:19], v[82:83]
    v_pk_add_f32 v[20:21], v[20:21], v[84:85]
    v_pk_add_f32 v[22:23], v[22:23], v[86:87]
    v_pk_add_f32 v[24:25], v[24:25], v[88:89]
    v_pk_add_f32 v[26:27], v[26:27], v[90:91]
    v_pk_add_f32 v[28:29], v[28:29], v[92:93]
    v_pk_add_f32 v[30:31], v[30:31], v[94:95]
    buffer_store_dwordx4 v[16:19], v182, s[52:55], s80 offen offset:128
    buffer_store_dwordx4 v[20:23], v182, s[52:55], s80 offen offset:160
    buffer_store_dwordx4 v[24:27], v182, s[52:55], s80 offen offset:192
    buffer_store_dwordx4 v[28:31], v182, s[52:55], s80 offen offset:224
    s_waitcnt vmcnt(0) lgkmcnt(0)
    s_mov_b64 exec, -1
    s_branch K2_FB8
K2_XO9:
    v_mov_b32 v60, v16
    v_mov_b32 v61, v17
    v_mov_b32 v62, v18
    v_mov_b32 v63, v19
    s_branch K2_XD9
K2_XO10:
    v_mov_b32 v60, v20
    v_mov_b32 v61, v21
    v_mov_b32 v62, v22
    v_mov_b32 v63, v23
    s_branch K2_XD10
K2_WREST:
    s_add_u32 s59, s59, 1
    s_cmp_lg_u32 s59, 1
    s_cbranch_scc1 K2_W11_1
    buffer_load_dwordx4 v[192:195], v191, s[36:39], s86 offen offset:0
    buffer_load_dwordx4 v[196:199], v191, s[36:39], s86 offen offset:1024
    buffer_load_dwordx4 v[200:203], v191, s[36:39], s86 offen offset:2048
    buffer_load_dwordx4 v[204:207], v191, s[36:39], s86 offen offset:3072
    s_add_u32 s86, s86, 4096
    s_branch K2_FINAL
K2_W11_1:
    s_cmp_lg_u32 s59, 2
    s_cbranch_scc1 K2_W11_2
    buffer_load_dwordx4 v[208:211], v191, s[36:39], s86 offen offset:0
    buffer_load_dwordx4 v[212:215], v191, s[36:39], s86 offen offset:1024
    buffer_load_dwordx4 v[216:219], v191, s[36:39], s86 offen offset:2048
    buffer_load_dwordx4 v[220:223], v191, s[36:39], s86 offen offset:3072
    s_add_u32 s86, s86, 4096
    s_branch K2_FINAL
K2_W11_2:
    s_cmp_lg_u32 s59, 3
    s_cbranch_scc1 K2_W11_3
    buffer_load_dwordx4 v[224:227], v191, s[36:39], s86 offen offset:0
    buffer_load_dwordx4 v[228:231], v191, s[36:39], s86 offen offset:1024
    buffer_load_dwordx4 v[232:235], v191, s[36:39], s86 offen offset:2048
    buffer_load_dwordx4 v[236:239], v191, s[36:39], s86 offen offset:3072
    s_add_u32 s86, s86, 4096
    s_branch K2_FINAL
K2_W11_3:
    buffer_load_dwordx4 v[240:243], v191, s[36:39], s86 offen offset:0
    buffer_load_dwordx4 v[244:247], v191, s[36:39], s86 offen offset:1024
    buffer_load_dwordx4 v[248:251], v191, s[36:39], s86 offen offset:2048
    buffer_load_dwordx4 v[252:255], v191, s[36:39], s86 offen offset:3072
    s_add_u32 s86, s86, 4294955008
    s_branch K2_FINAL
K2_NOA:
    buffer_load_dwordx2 v[232:233], v232, s[44:47], 0 offen
    buffer_load_dwordx2 v[234:235], v234, s[44:47], 0 offen
    buffer_load_dwordx4 v126, s[24:27], s58 offen offset:2048  lds
    buffer_load_dwordx4 v127, s[24:27], 0 offen offset:3072  lds
    s_mov_b32 s78, -1
    s_mov_b32 s59, 0
    s_add_u32 s86, s99, 262144
    s_mov_b64 s[74:75], 0
    s_bitset1_b64 s[74:75], s68
    s_bitset1_b64 s[74:75], s69
    s_bitset1_b64 s[74:75], s70
    s_bitset1_b64 s[74:75], s71
    s_lshl_b32 s87, s76, 1
    s_lshr_b64 s[74:75], s[74:75], s87
    s_or_b32 s74, s74, 1
    s_lshl_b64 s[74:75], s[74:75], 1
    s_mov_b32 s73, 0
    s_lshl_b32 s80, s73, 8
    s_or_b32 s80, s80, 16
    s_cmp_gt_u32 s71, s87
    s_cselect_b32 s73, s80, s73
    s_lshl_b32 s80, s73, 8
    s_or_b32 s80, s80, 12
    s_cmp_lg_u32 s70, s71
    s_cselect_b32 s80, s80, s73
    s_cmp_gt_u32 s70, s87
    s_cselect_b32 s73, s80, s73
    s_lshl_b32 s80, s73, 8
    s_or_b32 s80, s80, 8
    s_cmp_lg_u32 s69, s70
    s_cselect_b32 s80, s80, s73
    s_cmp_gt_u32 s69, s87
    s_cselect_b32 s73, s80, s73
    s_lshl_b32 s80, s73, 8
    s_or_b32 s80, s80, 4
    s_cmp_lg_u32 s68, s69
    s_cselect_b32 s80, s80, s73
    s_cmp_gt_u32 s68, s87
    s_cselect_b32 s73, s80, s73
    s_mov_b32 s3, s73
    s_mov_b32 s22, 0
    s_cmp_ge_u32 s87, s68
    s_addc_u32 s22, s22, 0
    s_cmp_ge_u32 s87, s69
    s_addc_u32 s22, s22, 0
    s_cmp_ge_u32 s87, s70
    s_addc_u32 s22, s22, 0
    s_cmp_ge_u32 s87, s71
    s_addc_u32 s22, s22, 0
    s_lshl_b32 s22, s22, 2
    s_lshl_b32 s80, s76, 11
    v_add_u32 v172, s80, v201
    s_mul_i32 s80, s76, 768
    s_add_u32 s80, s80, 53248
    s_add_u32 s81, s80, 256
    v_and_b32 v216, 15, v184
    v_cmp_eq_u32 vcc, 0, v176
    v_lshl_add_u32 v220, v216, 4, s80
    v_lshl_add_u32 v221, v216, 3, s81
    v_mov_b32 v217, 80128
    v_cndmask_b32 v174, v220, v217, vcc
    v_cndmask_b32 v175, v221, v217, vcc
    s_sub_u32 s76, s77, s76
    s_sub_u32 s76, s76, 1
    v_lshrrev_b32 v216, 3, v185
    v_lshlrev_b32 v240, 9, v216
    v_and_b32 v217, 1, v185
    v_lshl_or_b32 v240, v217, 3, v240
    v_and_b32 v218, 6, v185
    v_or_b32 v240, v240, v218
    v_lshrrev_b32 v216, 4, v185
    v_mul_u32_u24 v216, 384, v216
    v_bfe_u32 v219, v185, 1, 3
    v_lshl_or_b32 v219, v217, 3, v219
    v_add_u32 v216, 53248, v216
    v_lshl_add_u32 v241, v219, 4, v216
    v_lshl_add_u32 v242, v219, 3, v216
    s_waitcnt vmcnt(0) lgkmcnt(0)
    v_mov_b32 v221, 0x3f80
    s_mov_b32 s81, 0xffff0000
    s_mov_b32 s82, 0x01000100
    v_bfe_u32 v216, v228, 9, 1
    v_lshlrev_b32 v216, 4, v216
    v_alignbit_b32 v232, v233, v232, v216
    v_lshrrev_b32 v233, v216, v233
    v_lshlrev_b32 v216, 16, v232
    v_and_b32 v217, s81, v232
    v_lshlrev_b32 v218, 16, v233
    v_sub_f32 v216, v222, v216
    v_sub_f32 v217, v223, v217
    v_sub_f32 v218, v224, v218
    v_cvt_pk_bf16_f32 v232, v216, v217
    v_cvt_pk_bf16_f32 v233, v218, v218
    v_lshlrev_b32 v216, 16, v232
    v_and_b32 v217, s81, v232
    v_and_b32 v218, s81, v233
    v_mul_f32 v216, v216, v216
    v_fmac_f32 v216, v217, v217
    v_fmac_f32 v216, v218, v218
    v_cmp_gt_u32 vcc, 1073741824, v228
    v_cvt_pk_bf16_f32 v236, v216, v216
    v_perm_b32 v237, v230, v230, s82
    v_bfe_u32 v217, v230, 16, 3
    v_lshl_add_u32 v216, v217, 4, v240
    v_lshl_add_u32 v217, v217, 1, v241
    s_mov_b64 exec, vcc
    ds_write_b16 v216, v221 offset:0
    ds_write_b16 v216, v232 offset:128
    ds_write_b16_d16_hi v216, v232 offset:256
    ds_write_b16 v216, v233 offset:384
    ds_write_b16 v217, v221 offset:0
    ds_write_b64 v242, v[236:237] offset:256
    s_mov_b64 exec, -1
    s_lshl_b32 s80, s60, 2
    s_add_u32 s80, s80, 32
    s_cmp_ge_u32 s80, s72
    s_cbranch_scc1 K2_ND12
    v_mov_b32 v221, 0x3f80
    s_mov_b32 s81, 0xffff0000
    s_mov_b32 s82, 0x01000100
    v_bfe_u32 v216, v229, 9, 1
    v_lshlrev_b32 v216, 4, v216
    v_alignbit_b32 v234, v235, v234, v216
    v_lshrrev_b32 v235, v216, v235
    v_lshlrev_b32 v216, 16, v234
    v_and_b32 v217, s81, v234
    v_lshlrev_b32 v218, 16, v235
    v_sub_f32 v216, v225, v216
    v_sub_f32 v217, v226, v217
    v_sub_f32 v218, v227, v218
    v_cvt_pk_bf16_f32 v234, v216, v217
    v_cvt_pk_bf16_f32 v235, v218, v218
    v_lshlrev_b32 v216, 16, v234
    v_and_b32 v217, s81, v234
    v_and_b32 v218, s81, v235
    v_mul_f32 v216, v216, v216
    v_fmac_f32 v216, v217, v217
    v_fmac_f32 v216, v218, v218
    v_cmp_gt_u32 vcc, 1073741824, v229
    v_cvt_pk_bf16_f32 v236, v216, v216
    v_perm_b32 v237, v231, v231, s82
    v_bfe_u32 v217, v231, 16, 3
    v_lshl_add_u32 v216, v217, 4, v240
    v_lshl_add_u32 v217, v217, 1, v241
    s_mov_b64 exec, vcc
    ds_write_b16 v216, v221 offset:32768
    ds_write_b16 v216, v234 offset:32896
    ds_write_b16_d16_hi v216, v234 offset:33024
    ds_write_b16 v216, v235 offset:33152
    ds_write_b16 v217, v221 offset:12288
    ds_write_b64 v242, v[236:237] offset:12544
    s_mov_b64 exec, -1
K2_ND12:
    s_waitcnt lgkmcnt(0)
    ds_read_b128 v[104:107], v177 offset:0
    ds_read_b128 v[108:111], v179 offset:0
    ds_read2_b64 v[124:127], v173 offset0:16 offset1:24
    s_barrier
    s_branch K2_READY
K2_IDLE:
    s_lshl_b32 s87, s89, 1
    s_mov_b32 s23, 0
    s_cmp_lg_u32 s67, s68
    s_cselect_b32 s80, 1, 0
    s_cmp_lg_u32 s67, s87
    s_cselect_b32 s80, s80, 0
    s_or_b32 s23, s23, s80
    s_cmp_lg_u32 s68, s69
    s_cselect_b32 s80, 2, 0
    s_cmp_lg_u32 s68, s87
    s_cselect_b32 s80, s80, 0
    s_or_b32 s23, s23, s80
    s_cmp_lg_u32 s69, s70
    s_cselect_b32 s80, 4, 0
    s_cmp_lg_u32 s69, s87
    s_cselect_b32 s80, s80, 0
    s_or_b32 s23, s23, s80
    s_cmp_lg_u32 s70, s71
    s_cselect_b32 s80, 8, 0
    s_cmp_lg_u32 s70, s87
    s_cselect_b32 s80, s80, 0
    s_or_b32 s23, s23, s80
    s_cmp_lg_u32 s71, s72
    s_cselect_b32 s80, 16, 0
    s_cmp_lg_u32 s71, s87
    s_cselect_b32 s80, s80, 0
    s_or_b32 s23, s23, s80
    s_cmp_lt_u32 s87, s72
    s_cselect_b32 s80, 32, 0
    s_or_b32 s23, s23, s80
    s_cmp_lg_u32 s64, 0
    s_cselect_b32 s23, 31, s23
    s_mov_b32 s21, 0
    s_cmp_ge_u32 s87, s68
    s_addc_u32 s21, s21, 0
    s_cmp_ge_u32 s87, s69
    s_addc_u32 s21, s21, 0
    s_cmp_ge_u32 s87, s70
    s_addc_u32 s21, s21, 0
    s_cmp_ge_u32 s87, s71
    s_addc_u32 s21, s21, 0
    v_and_b32 v104, 15, v184
    v_and_b32 v106, 48, v184
    v_mul_u32_u24 v107, 528, v104
    v_add_u32 v107, v107, v106
    v_lshrrev_b32 v105, 3, v104
    v_lshrrev_b32 v105, v105, s23
    v_mov_b32 v108, 80128
    v_and_b32 v109, 1, v105
    v_cmp_ne_u32 vcc, 0, v109
    v_add_u32 v110, 84608, v107
    s_nop 0
    v_cndmask_b32 v173, v108, v110, vcc
    v_and_b32 v109, 4, v105
    v_cmp_ne_u32 vcc, 0, v109
    v_add_u32 v110, 93056, v107
    s_nop 0
    v_cndmask_b32 v174, v108, v110, vcc
    v_and_b32 v109, 16, v105
    v_cmp_ne_u32 vcc, 0, v109
    v_add_u32 v110, 101504, v107
    s_nop 0
    v_cndmask_b32 v175, v108, v110, vcc
    s_branch K2_DONE
K2_OVER:
    s_cmp_lg_u32 s64, 0
    s_cbranch_scc1 K2_FITS
    s_mov_b32 s64, 1
    s_mov_b32 s65, 0
    s_mov_b32 s66, s88
    v_add_u32 v200, s87, v200
    v_lshrrev_b32 v216, 1, v184
    s_lshl_b32 s80, s60, 8
    v_lshl_add_u32 v218, v216, 3, s80
    v_lshl_add_u32 v197, v216, 3, s60
    v_lshrrev_b32 v218, 1, v218
    v_add_u32 v218, 40960, v218
    buffer_store_dword v200, v218, s[52:55], 0 offen
    v_lshlrev_b32 v216, 4, v185
    buffer_store_dwordx4 v[168:171], v216, s[52:55], 0 offen
    v_add_u32 v216, 8192, v216
    buffer_store_dwordx4 v[168:171], v216, s[52:55], 0 offen
    v_add_u32 v216, 8192, v216
    buffer_store_dwordx4 v[168:171], v216, s[52:55], 0 offen
    v_add_u32 v216, 8192, v216
    buffer_store_dwordx4 v[168:171], v216, s[52:55], 0 offen
    v_add_u32 v216, 8192, v216
    buffer_store_dwordx4 v[168:171], v216, s[52:55], 0 offen
    v_add_u32 v216, 8192, v216
    s_waitcnt vmcnt(0) lgkmcnt(0)
    s_barrier
    s_branch K2_SETUP
K2_NEXT:
    s_waitcnt vmcnt(0) lgkmcnt(0)
    s_barrier
    s_mov_b32 s63, 0
    s_add_u32 s65, s65, s88
    s_cmp_ge_u32 s65, s66
    s_cbranch_scc1 K2_LAST
    s_cmp_eq_u32 s88, 0
    s_cbranch_scc1 K2_LAST
    v_lshlrev_b32 v220, 4, v185
    v_add_u32 v221, 65536, v220
    ds_write_b128 v220, v[168:171] offset:0
    ds_write_b128 v220, v[168:171] offset:8192
    ds_write_b128 v220, v[168:171] offset:16384
    ds_write_b128 v220, v[168:171] offset:24576
    ds_write_b128 v220, v[168:171] offset:32768
    ds_write_b128 v220, v[168:171] offset:40960
    ds_write_b128 v220, v[168:171] offset:49152
    ds_write_b128 v220, v[168:171] offset:57344
    v_cmp_gt_u32 vcc, 480, v185
    v_mov_b32 v248, 1073741824
    v_mov_b32 v249, 1073741824
    v_mov_b32 v250, 1073741824
    v_mov_b32 v251, 1073741824
    s_mov_b64 exec, vcc
    v_cmp_gt_u32 vcc, 224, v185
    ds_write_b128 v221, v[168:171]
    s_mov_b64 exec, vcc
    ds_write_b128 v221, v[248:251] offset:7680
    s_mov_b64 exec, -1
K2_SETUP:
    v_lshrrev_b32 v216, 1, v184
    s_lshl_b32 s80, s60, 8
    v_lshl_add_u32 v218, v216, 3, s80
    v_lshl_add_u32 v197, v216, 3, s60
    buffer_load_dwordx2 v[192:193], v218, s[32:35], 0 offen
    v_lshrrev_b32 v218, 1, v218
    v_add_u32 v218, 40960, v218
    buffer_load_dword v218, v218, s[52:55], 0 offen sc1
    v_mul_u32_u24 v197, 640, v197
    v_and_b32 v196, 1, v184
    v_lshlrev_b32 v196, 1, v196
    v_lshlrev_b32 v201, 4, v184
    v_add_u32 v245, 4096, v201
    v_add_u32 v246, 8192, v201
    v_add_u32 v247, 12288, v201
    s_waitcnt vmcnt(0) lgkmcnt(0)
    v_and_b32 v216, 1023, v192
    v_lshrrev_b32 v217, 20, v193
    v_sub_u32 v216, v217, v216
    v_sub_u32 v216, v218, v216
    s_add_u32 s80, s65, 757
    v_cmp_le_u32 vcc, s65, v216
    v_cmp_ge_u32 s[82:83], s80, v218
    s_nop 1
    s_and_b64 vcc, vcc, s[82:83]
    s_nop 1
    v_cndmask_b32 v192, 0, v192, vcc
    v_cndmask_b32 v193, 0, v193, vcc
    s_branch K2_BATCH
K2_LAST:
    v_lshlrev_b32 v0, 6, v185
    v_lshrrev_b32 v1, 4, v185
    v_mul_u32_u24 v1, 528, v1
    v_and_b32 v2, 15, v185
    v_lshl_add_u32 v1, v2, 5, v1
    v_add_u32 v1, 84608, v1
    buffer_load_dwordx4 v[4:7], v0, s[52:55], 0 offen offset:0 sc1
    buffer_load_dwordx4 v[8:11], v0, s[52:55], 0 offen offset:16 sc1
    buffer_load_dwordx4 v[12:15], v0, s[52:55], 0 offen offset:32 sc1
    buffer_load_dwordx4 v[16:19], v0, s[52:55], 0 offen offset:48 sc1
    s_waitcnt vmcnt(0)
    v_cvt_pk_bf16_f32 v20, v4, v5
    v_cvt_pk_bf16_f32 v21, v6, v7
    v_cvt_pk_bf16_f32 v22, v8, v9
    v_cvt_pk_bf16_f32 v23, v10, v11
    v_cvt_pk_bf16_f32 v24, v12, v13
    v_cvt_pk_bf16_f32 v25, v14, v15
    v_cvt_pk_bf16_f32 v26, v16, v17
    v_cvt_pk_bf16_f32 v27, v18, v19
    ds_write_b128 v1, v[20:23] offset:0
    ds_write_b128 v1, v[24:27] offset:16
    v_cmp_gt_u32 vcc, 128, v185
    v_add_u32 v0, 32768, v0
    s_waitcnt lgkmcnt(0)
    s_and_saveexec_b64 s[4:5], vcc
    s_cbranch_execz K2_LAST2
    buffer_load_dwordx4 v[4:7], v0, s[52:55], 0 offen offset:0 sc1
    buffer_load_dwordx4 v[8:11], v0, s[52:55], 0 offen offset:16 sc1
    buffer_load_dwordx4 v[12:15], v0, s[52:55], 0 offen offset:32 sc1
    buffer_load_dwordx4 v[16:19], v0, s[52:55], 0 offen offset:48 sc1
    s_waitcnt vmcnt(0)
    v_cvt_pk_bf16_f32 v20, v4, v5
    v_cvt_pk_bf16_f32 v21, v6, v7
    v_cvt_pk_bf16_f32 v22, v8, v9
    v_cvt_pk_bf16_f32 v23, v10, v11
    v_cvt_pk_bf16_f32 v24, v12, v13
    v_cvt_pk_bf16_f32 v25, v14, v15
    v_cvt_pk_bf16_f32 v26, v16, v17
    v_cvt_pk_bf16_f32 v27, v18, v19
    ds_write_b128 v1, v[20:23] offset:16896
    ds_write_b128 v1, v[24:27] offset:16912
K2_LAST2:
    s_mov_b64 exec, -1
    s_branch K2_FINAL
CODE_END:
    s_endpgm
.section .rodata,"a"
.p2align 6
.amdhsa_kernel prep_kernel
  .amdhsa_next_free_vgpr 124
  .amdhsa_next_free_sgpr 96
  .amdhsa_accum_offset 124
  .amdhsa_group_segment_fixed_size 0
  .amdhsa_kernarg_size 88
  .amdhsa_user_sgpr_count 2
  .amdhsa_user_sgpr_kernarg_segment_ptr 1
  .amdhsa_system_sgpr_workgroup_id_x 1
  .amdhsa_float_denorm_mode_32 3
.end_amdhsa_kernel
.p2align 6
.amdhsa_kernel edge_kernel
  .amdhsa_next_free_vgpr 256
  .amdhsa_next_free_sgpr 102
  .amdhsa_accum_offset 256
  .amdhsa_group_segment_fixed_size 0
  .amdhsa_kernarg_size 88
  .amdhsa_user_sgpr_count 2
  .amdhsa_user_sgpr_kernarg_segment_ptr 1
  .amdhsa_system_sgpr_workgroup_id_x 1
  .amdhsa_float_denorm_mode_32 3
.end_amdhsa_kernel
```
